```python
import torch

def _softmax(x, axis=-1):
    return torch.softmax(x, dim=axis)
def _gelu(x):
    return torch.nn.functional.gelu(x, approximate="tanh")
def _silu(x):
    return torch.nn.functional.silu(x)
def _sigmoid(x):
    return torch.sigmoid(x)
def _layernorm(x, axis=-1, eps=1e-5):
    m = x.mean(dim=axis, keepdim=True)
    v = x.var(dim=axis, keepdim=True, unbiased=False)
    return (x - m) / torch.sqrt(v + eps)
def _scatter_add(tgt, idx, src, axis=0):
    return tgt.clone().index_add_(axis, idx, src)
def _segment_sum(src, seg, n):
    out = torch.zeros((n,) + src.shape[1:], dtype=src.dtype)
    return out.index_add_(0, seg, src)
def _pad(x, pw):
    flat = tuple(v for pair in reversed(pw) for v in pair)
    return torch.nn.functional.pad(x, flat)

kernel_name = 'concat_heads__gqa_block_cached__mha_block_cached__near_ridge'

def setup_inputs():

    _w = (lambda a: (lambda t: t.to(torch.bfloat16) if t.is_floating_point() else t)(torch.as_tensor(a)))
    def _A_setup():
        B, Sq, D = 16, 64, 576
        Hq, Hkv, Sk, Dh = 32, 16, 512, 128
        assert Hq % Hkv == 0, (Hq, Hkv)
        return {
            "x": _w((lambda *s: torch.randn(*s, dtype=torch.bfloat16) * 0.8)(B, Sq, D)),
            "k_cache": _w((lambda *s: torch.randn(*s, dtype=torch.bfloat16) * 0.8)(B, Hkv, Sk, Dh)),
            "v_cache": _w((lambda *s: torch.randn(*s, dtype=torch.bfloat16) * 0.05)(B, Hkv, Sk, Dh)),
            "wq": _w((lambda *s: torch.randn(*s, dtype=torch.bfloat16) * 0.8)(D, Hq * Dh) * (D ** -0.5)),
            "wo": _w((lambda *s: torch.randn(*s, dtype=torch.bfloat16) * 0.05)(Hq * Dh, D) * ((Hq * Dh) ** -0.5)),
        }
    _A_in = _A_setup()

    def _B_setup():
        B, Sq, D = 16, 64, 576
        H, Sk, Dh = 32, 512, 128
        return {
            "x": _w((lambda *s: torch.randn(*s, dtype=torch.bfloat16) * 0.8)(B, Sq, D)),
            "k_cache": _w((lambda *s: torch.randn(*s, dtype=torch.bfloat16) * 0.8)(B, H, Sk, Dh)),
            "v_cache": _w((lambda *s: torch.randn(*s, dtype=torch.bfloat16) * 0.05)(B, H, Sk, Dh)),
            "wq": _w((lambda *s: torch.randn(*s, dtype=torch.bfloat16) * 0.8)(D, H * Dh) * (D ** -0.5)),
            "wo": _w((lambda *s: torch.randn(*s, dtype=torch.bfloat16) * 0.05)(H * Dh, D) * ((H * Dh) ** -0.5)),
        }
    _B_in = _B_setup()

    return {
        "A_x": _A_in["x"],
        "A_k_cache": _A_in["k_cache"],
        "A_v_cache": _A_in["v_cache"],
        "A_wq": _A_in["wq"],
        "A_wo": _A_in["wo"],
        "B_x": _B_in["x"],
        "B_k_cache": _B_in["k_cache"],
        "B_v_cache": _B_in["v_cache"],
        "B_wq": _B_in["wq"],
        "B_wo": _B_in["wo"],
    }

def reference(A_x, A_k_cache, A_v_cache, A_wq, A_wo, B_x, B_k_cache, B_v_cache, B_wq, B_wo):
    def _A_ref(x, k_cache, v_cache, wq, wo):
        B, Sq, D = x.shape
        Hq, Dh = 32, 128
        Hkv = k_cache.shape[1]
        rep = Hq // Hkv
        q = (lambda x, *d: x.permute(*d))((x @ wq).reshape(B, Sq, Hq, Dh), 0, 2, 1, 3)
        k = (lambda x, n, axis: torch.repeat_interleave(x, n, dim=axis))(k_cache, rep, axis=1)
        v = (lambda x, n, axis: torch.repeat_interleave(x, n, dim=axis))(v_cache, rep, axis=1)
        scores = torch.einsum("bhqd,bhkd->bhqk", q, k) * (Dh ** -0.5)
        p = _softmax(scores, axis=-1)
        o = torch.einsum("bhqk,bhkd->bhqd", p, v)
        return (lambda x, *d: x.permute(*d))(o, 0, 2, 1, 3).reshape(B, Sq, Hq * Dh) @ wo

    def _B_ref(x, k_cache, v_cache, wq, wo):
        B, Sq, D = x.shape
        H, Dh = 32, 128
        q = (lambda x, *d: x.permute(*d))((x @ wq).reshape(B, Sq, H, Dh), 0, 2, 1, 3)
        scores = torch.einsum("bhqd,bhkd->bhqk", q, k_cache) * (Dh ** -0.5)
        p = _softmax(scores, axis=-1)
        o = torch.einsum("bhqk,bhkd->bhqd", p, v_cache)
        return (lambda x, *d: x.permute(*d))(o, 0, 2, 1, 3).reshape(B, Sq, H * Dh) @ wo

    a = _A_ref(A_x, A_k_cache, A_v_cache, A_wq, A_wo)
    b = _B_ref(B_x, B_k_cache, B_v_cache, B_wq, B_wo)
    return torch.concatenate([a, b], axis=-1)
```

```asm
; @launch grid=(256,1,1) block=(512,1,1) lds=163840
.amdgcn_target "amdgcn-amd-amdhsa--gfx950"
.text
.globl concat_heads__gqa_block_cached__mha_block_cached__near_ridge_kernel
.p2align 8
.type concat_heads__gqa_block_cached__mha_block_cached__near_ridge_kernel,@function
concat_heads__gqa_block_cached__mha_block_cached__near_ridge_kernel:
    s_cmp_ge_u32 s2, 256
    s_cbranch_scc1 L_end
    s_load_dwordx2 s[68:69], s[0:1], 96
    s_load_dwordx4 s[80:83], s[0:1], 80
    s_load_dwordx2 s[92:93], s[0:1], 40
    s_load_dwordx2 s[94:95], s[0:1], 64
    s_and_b32 s5, s2, 7
    s_lshr_b32 s6, s2, 3
    s_and_b32 s6, s6, 1
    s_lshr_b32 s7, s2, 4
    s_mul_i32 s46, s6, 40
    s_add_u32 s0, s0, s46
    s_addc_u32 s1, s1, 0
    s_load_dwordx8 s[56:63], s[0:1], 0
    s_load_dwordx2 s[70:71], s[0:1], 32
    s_getpc_b64 s[46:47]
L_pc:
    s_sub_u32 s46, s46, L_pc-concat_heads__gqa_block_cached__mha_block_cached__near_ridge_kernel
    s_subb_u32 s47, s47, 0
    s_and_b32 s48, s2, 0xf8
    v_lshrrev_b32 v1, 6, v0
    v_add_lshl_u32 v6, v1, s48, 7
    v_min_u32 v6, L_end-concat_heads__gqa_block_cached__mha_block_cached__near_ridge_kernel, v6
    v_mov_b32 v7, s47
    v_add_co_u32 v6, vcc, s46, v6
    s_nop 1
    v_addc_co_u32 v7, vcc, 0, v7, vcc
    global_load_dword v68, v[6:7], off
    v_lshrrev_b32 v1, 6, v0
    v_and_b32 v0, 63, v0
    v_readfirstlane_b32 s3, v1
    v_lshrrev_b32 v2, 4, v0
    v_and_b32 v3, 15, v0
    s_and_b32 s4, s3, 3
    v_lshrrev_b32 v4, 3, v0
    v_and_b32 v5, 7, v0
    v_mul_u32_u24 v7, 1152, v4
    v_add_u32 v6, 0, v2
    v_xor_b32 v6, v6, v5
    v_lshl_add_u32 v6, v6, 4, v7
    v_add_u32 v14, 0, v6
    v_add_u32 v6, 4, v2
    v_xor_b32 v6, v6, v5
    v_lshl_add_u32 v6, v6, 4, v7
    v_add_u32 v15, 8192, v6
    v_and_b32 v1, 1, v2
    v_lshlrev_b32 v1, 1, v1
    v_xor_b32 v1, v1, v5
    v_lshlrev_b32 v1, 4, v1
    v_lshl_add_u32 v22, v4, 13, v1
    v_xor_b32 v23, 64, v22
    s_lshl_b32 s35, s5, 10
    s_lshl_b32 s46, s4, 7
    s_add_u32 s35, s35, s46
    s_mov_b32 s37, 0
    s_mul_i32 s46, s5, 0
    s_add_u32 s46, s46, s7
    s_mul_i32 s47, s46, 57
    s_lshr_b32 s47, s47, 9
    s_mul_i32 s47, s47, 9
    s_sub_u32 s39, s46, s47
    s_mov_b32 s36, s39
    s_mul_i32 s38, s7, 73728
    s_mul_i32 s46, s4, 18432
    s_add_u32 s38, s38, s46
    s_lshl_b32 s46, s7, 3
    s_add_u32 s46, s46, s5
    s_lshl_b32 s86, s46, 7
    s_add_u32 s86, s86, 33587200
    s_lshl_b32 s88, s7, 10
    s_add_u32 s88, s88, 33554432
    s_waitcnt lgkmcnt(0)
    s_mov_b32 s16, s56
    s_and_b32 s17, s57, 0xffff
    s_mov_b32 s18, 1179648
    s_mov_b32 s19, 0x20000
    s_mov_b32 s20, s62
    s_and_b32 s21, s63, 0xffff
    s_mov_b32 s22, 4718592
    s_mov_b32 s23, 0x20000
    s_cmp_ge_u32 s3, 4
    s_cbranch_scc1 L_pj
L_at:
    s_setprio 1
    s_mov_b32 s40, 0
    s_cmp_eq_u32 s6, 0
    s_cbranch_scc1 L_at_a
    s_lshl_b32 s46, s39, 7
    s_add_u32 s46, s46, s38
    s_and_b32 s47, s40, 3
    s_lshl_b32 s47, s47, 2
    s_add_u32 s47, s47, s4
    s_lshl_b32 s47, s47, 11
    s_add_u32 m0, s47, 131072
    s_add_u32 s40, s40, 1
    s_add_u32 s39, s39, 1
    s_cmp_eq_u32 s39, 9
    s_cselect_b32 s39, 0, s39
    buffer_load_dwordx4 v14, s[16:19], s46 offen offset:0 lds
    buffer_load_dwordx4 v15, s[16:19], s46 offen offset:1024 lds
    s_lshl_b32 s51, s4, 13
    s_add_u32 s51, s51, 98304
    s_lshl_b32 s46, s36, 19
    s_add_u32 s46, s46, s35
    s_mov_b32 m0, s51
    s_add_u32 s36, s36, 1
    buffer_load_dwordx4 v22, s[20:23], s46 offen offset:0 lds
    s_add_u32 s46, s46, 64512
    buffer_load_dwordx4 v23, s[20:23], s46 offen offset:1024 lds
    s_add_u32 s46, s46, 64512
    buffer_load_dwordx4 v22, s[20:23], s46 offen offset:2048 lds
    s_add_u32 s46, s46, 64512
    buffer_load_dwordx4 v23, s[20:23], s46 offen offset:3072 lds
    s_add_u32 m0, s51, 4096
    s_add_u32 s46, s46, 68608
    buffer_load_dwordx4 v22, s[20:23], s46 offen offset:0 lds
    s_add_u32 s46, s46, 64512
    buffer_load_dwordx4 v23, s[20:23], s46 offen offset:1024 lds
    s_add_u32 s46, s46, 64512
    buffer_load_dwordx4 v22, s[20:23], s46 offen offset:2048 lds
    s_add_u32 s46, s46, 64512
    buffer_load_dwordx4 v23, s[20:23], s46 offen offset:3072 lds
    s_cmp_eq_u32 s36, 9
    s_cselect_b32 s36, 0, s36
    s_add_u32 s37, s37, 1
    s_cmp_eq_u32 s37, 9
    s_cselect_b32 s47, 512, 0
    s_add_u32 s35, s35, s47
    s_branch L_at_b
L_at_a:
    s_mov_b32 s76, s94
    s_and_b32 s77, s95, 0xffff
    s_mov_b32 s78, 4718592
    s_mov_b32 s79, 0x20000
    s_lshl_b32 s46, s7, 2
    s_add_u32 s46, s46, s4
    s_mul_i32 s46, s46, 73728
    s_lshl_b32 s47, s5, 10
    s_add_u32 s46, s46, s47
    v_lshrrev_b32 v1, 2, v0
    v_and_b32 v6, 3, v0
    v_lshlrev_b32 v6, 7, v6
    v_lshl_add_u32 v1, v1, 13, v6
    s_mov_b32 exec_hi, 15
    buffer_load_dword v47, v1, s[76:79], s46 offen
    s_mov_b64 exec, -1
    s_mov_b32 s72, s92
    s_and_b32 s73, s93, 0xffff
    s_mov_b32 s74, 1179648
    s_mov_b32 s75, 0x20000
    v_mul_u32_u24 v1, 1152, v0
    s_mul_i32 s48, s7, 73728
    s_add_u32 s46, s39, s4
    s_add_u32 s46, s46, 1
    s_mul_i32 s47, s46, 57
    s_lshr_b32 s47, s47, 9
    s_mul_i32 s47, s47, 9
    s_sub_u32 s46, s46, s47
    s_lshl_b32 s46, s46, 7
    s_add_u32 s46, s46, s48
    buffer_load_dword v44, v1, s[72:75], s46 offen
    s_add_u32 s46, s39, s4
    s_add_u32 s46, s46, 5
    s_mul_i32 s47, s46, 57
    s_lshr_b32 s47, s47, 9
    s_mul_i32 s47, s47, 9
    s_sub_u32 s46, s46, s47
    s_lshl_b32 s46, s46, 7
    s_add_u32 s46, s46, s48
    buffer_load_dword v45, v1, s[72:75], s46 offen
    s_lshl_b32 s46, s39, 7
    s_add_u32 s46, s46, s38
    s_and_b32 s47, s40, 3
    s_lshl_b32 s47, s47, 2
    s_add_u32 s47, s47, s4
    s_lshl_b32 s47, s47, 11
    s_add_u32 m0, s47, 131072
    s_add_u32 s40, s40, 1
    s_add_u32 s39, s39, 1
    s_cmp_eq_u32 s39, 9
    s_cselect_b32 s39, 0, s39
    buffer_load_dwordx4 v14, s[16:19], s46 offen offset:0 lds
    buffer_load_dwordx4 v15, s[16:19], s46 offen offset:1024 lds
    s_lshl_b32 s51, s4, 13
    s_add_u32 s51, s51, 98304
    s_lshl_b32 s46, s36, 19
    s_add_u32 s46, s46, s35
    s_mov_b32 m0, s51
    s_add_u32 s36, s36, 1
    buffer_load_dwordx4 v22, s[20:23], s46 offen offset:0 lds
    s_add_u32 s46, s46, 64512
    buffer_load_dwordx4 v23, s[20:23], s46 offen offset:1024 lds
    s_add_u32 s46, s46, 64512
    buffer_load_dwordx4 v22, s[20:23], s46 offen offset:2048 lds
    s_add_u32 s46, s46, 64512
    buffer_load_dwordx4 v23, s[20:23], s46 offen offset:3072 lds
    s_add_u32 m0, s51, 4096
    s_add_u32 s46, s46, 68608
    buffer_load_dwordx4 v22, s[20:23], s46 offen offset:0 lds
    s_add_u32 s46, s46, 64512
    buffer_load_dwordx4 v23, s[20:23], s46 offen offset:1024 lds
    s_add_u32 s46, s46, 64512
    buffer_load_dwordx4 v22, s[20:23], s46 offen offset:2048 lds
    s_add_u32 s46, s46, 64512
    buffer_load_dwordx4 v23, s[20:23], s46 offen offset:3072 lds
    s_cmp_eq_u32 s36, 9
    s_cselect_b32 s36, 0, s36
    s_add_u32 s37, s37, 1
    s_cmp_eq_u32 s37, 9
    s_cselect_b32 s47, 512, 0
    s_add_u32 s35, s35, s47
    s_call_b64 s[64:65], F_atset
    s_call_b64 s[64:65], F_x
    s_lshl_b32 s51, s4, 13
    s_add_u32 s51, s51, 32768
    s_call_b64 s[64:65], F_w
    s_waitcnt vmcnt(10)
    s_barrier
    s_call_b64 s[64:65], F_x
    s_call_b64 s[64:65], F_x
    s_lshl_b32 s46, s39, 7
    s_add_u32 s46, s46, s38
    s_add_u32 s40, s40, 1
    s_add_u32 s39, s39, 1
    s_cmp_eq_u32 s39, 9
    s_cselect_b32 s39, 0, s39
    buffer_load_dwordx4 v[180:183], v14, s[16:19], s46 offen offset:0
    buffer_load_dwordx4 v[184:187], v15, s[16:19], s46 offen offset:1024
    s_lshl_b32 s46, s39, 7
    s_add_u32 s46, s46, s38
    s_add_u32 s40, s40, 1
    s_add_u32 s39, s39, 1
    s_cmp_eq_u32 s39, 9
    s_cselect_b32 s39, 0, s39
    buffer_load_dwordx4 v[188:191], v14, s[16:19], s46 offen offset:0
    buffer_load_dwordx4 v[192:195], v15, s[16:19], s46 offen offset:1024
    s_lshl_b32 s46, s39, 7
    s_add_u32 s46, s46, s38
    s_add_u32 s40, s40, 1
    s_add_u32 s39, s39, 1
    s_cmp_eq_u32 s39, 9
    s_cselect_b32 s39, 0, s39
    buffer_load_dwordx4 v[196:199], v14, s[16:19], s46 offen offset:0
    buffer_load_dwordx4 v[200:203], v15, s[16:19], s46 offen offset:1024
    s_lshl_b32 s46, s39, 7
    s_add_u32 s46, s46, s38
    s_add_u32 s40, s40, 1
    s_add_u32 s39, s39, 1
    s_cmp_eq_u32 s39, 9
    s_cselect_b32 s39, 0, s39
    buffer_load_dwordx4 v[204:207], v14, s[16:19], s46 offen offset:0
    buffer_load_dwordx4 v[208:211], v15, s[16:19], s46 offen offset:1024
    s_lshl_b32 s46, s39, 7
    s_add_u32 s46, s46, s38
    s_add_u32 s40, s40, 1
    s_add_u32 s39, s39, 1
    s_cmp_eq_u32 s39, 9
    s_cselect_b32 s39, 0, s39
    buffer_load_dwordx4 v[212:215], v14, s[16:19], s46 offen offset:0
    buffer_load_dwordx4 v[216:219], v15, s[16:19], s46 offen offset:1024
    s_lshl_b32 s51, s4, 13
    s_add_u32 s51, s51, 65536
    s_call_b64 s[64:65], F_w
    s_waitcnt vmcnt(22)
    s_waitcnt lgkmcnt(0)
    s_barrier
    s_waitcnt vmcnt(16)
    ds_write_b128 v40, v[180:183] offset:0
    ds_write_b128 v40, v[184:187] offset:1024
    s_lshl_b32 s51, s4, 13
    s_add_u32 s51, s51, 98304
    s_call_b64 s[64:65], F_w
    s_waitcnt vmcnt(8)
    s_waitcnt lgkmcnt(0)
    s_barrier
    s_waitcnt vmcnt(22)
    ds_write_b128 v40, v[188:191] offset:8192
    ds_write_b128 v40, v[192:195] offset:9216
    s_lshl_b32 s51, s4, 13
    s_add_u32 s51, s51, 32768
    s_call_b64 s[64:65], F_w
    s_waitcnt vmcnt(8)
    s_waitcnt lgkmcnt(0)
    s_barrier
    s_waitcnt vmcnt(28)
    ds_write_b128 v40, v[196:199] offset:16384
    ds_write_b128 v40, v[200:203] offset:17408
    s_lshl_b32 s51, s4, 13
    s_add_u32 s51, s51, 65536
    s_call_b64 s[64:65], F_w
    s_waitcnt vmcnt(8)
    s_waitcnt lgkmcnt(0)
    s_barrier
    s_waitcnt vmcnt(34)
    ds_write_b128 v40, v[204:207] offset:24576
    ds_write_b128 v40, v[208:211] offset:25600
    s_lshl_b32 s51, s4, 13
    s_add_u32 s51, s51, 98304
    s_call_b64 s[64:65], F_w
    s_waitcnt vmcnt(8)
    s_waitcnt lgkmcnt(0)
    s_barrier
    s_waitcnt vmcnt(40)
    ds_write_b128 v40, v[212:215] offset:0
    ds_write_b128 v40, v[216:219] offset:1024
    s_lshl_b32 s51, s4, 13
    s_add_u32 s51, s51, 32768
    s_call_b64 s[64:65], F_w
    s_waitcnt vmcnt(8)
    s_waitcnt lgkmcnt(0)
    s_barrier
    s_lshl_b32 s51, s4, 13
    s_add_u32 s51, s51, 65536
    s_call_b64 s[64:65], F_w
    s_waitcnt vmcnt(8)
    s_waitcnt lgkmcnt(0)
    s_barrier
    s_sub_u32 s36, s36, 1
    s_cselect_b32 s36, 8, s36
    s_lshl_b32 s51, s4, 13
    s_add_u32 s51, s51, 98304
    s_call_b64 s[64:65], F_w
    s_waitcnt vmcnt(8)
    s_waitcnt lgkmcnt(0)
    s_barrier
    s_call_b64 s[64:65], F_kv
    s_call_b64 s[64:65], F_kv
    s_waitcnt vmcnt(0)
    s_waitcnt lgkmcnt(0)
    s_branch L_at_done
L_at_b:
    s_call_b64 s[64:65], F_atset
    s_call_b64 s[64:65], F_x
    s_lshl_b32 s51, s4, 13
    s_add_u32 s51, s51, 32768
    s_call_b64 s[64:65], F_w
    s_waitcnt vmcnt(10)
    s_barrier
    s_call_b64 s[64:65], F_x
    s_call_b64 s[64:65], F_x
    s_lshl_b32 s51, s4, 13
    s_add_u32 s51, s51, 65536
    s_call_b64 s[64:65], F_w
    s_waitcnt vmcnt(12)
    s_waitcnt lgkmcnt(0)
    s_barrier
    s_call_b64 s[64:65], F_x
    s_lshl_b32 s51, s4, 13
    s_add_u32 s51, s51, 98304
    s_call_b64 s[64:65], F_w
    s_waitcnt vmcnt(10)
    s_waitcnt lgkmcnt(0)
    s_barrier
    s_call_b64 s[64:65], F_x
    s_lshl_b32 s51, s4, 13
    s_add_u32 s51, s51, 32768
    s_call_b64 s[64:65], F_w
    s_waitcnt vmcnt(10)
    s_waitcnt lgkmcnt(0)
    s_barrier
    s_call_b64 s[64:65], F_x
    s_lshl_b32 s51, s4, 13
    s_add_u32 s51, s51, 65536
    s_call_b64 s[64:65], F_w
    s_waitcnt vmcnt(10)
    s_waitcnt lgkmcnt(0)
    s_barrier
    s_call_b64 s[64:65], F_x
    s_lshl_b32 s51, s4, 13
    s_add_u32 s51, s51, 98304
    s_call_b64 s[64:65], F_w
    s_waitcnt vmcnt(10)
    s_waitcnt lgkmcnt(0)
    s_barrier
    s_call_b64 s[64:65], F_x
    s_lshl_b32 s51, s4, 13
    s_add_u32 s51, s51, 32768
    s_call_b64 s[64:65], F_w
    s_waitcnt vmcnt(10)
    s_waitcnt lgkmcnt(0)
    s_barrier
    s_lshl_b32 s51, s4, 13
    s_add_u32 s51, s51, 65536
    s_call_b64 s[64:65], F_w
    s_waitcnt vmcnt(8)
    s_waitcnt lgkmcnt(0)
    s_barrier
    s_sub_u32 s36, s36, 1
    s_cselect_b32 s36, 8, s36
    s_lshl_b32 s51, s4, 13
    s_add_u32 s51, s51, 98304
    s_call_b64 s[64:65], F_w
    s_waitcnt vmcnt(8)
    s_waitcnt lgkmcnt(0)
    s_barrier
    s_call_b64 s[64:65], F_kv
    s_call_b64 s[64:65], F_kv
    s_waitcnt vmcnt(8)
    s_waitcnt lgkmcnt(0)
L_at_done:
    s_setprio 0
    s_branch L_stage
F_atset:
    s_mov_b32 s8, s58
    s_and_b32 s9, s59, 0xffff
    s_lshl_b32 s10, 33554432, s6
    s_mov_b32 s11, 0x20000
    s_mov_b32 s12, s60
    s_and_b32 s13, s61, 0xffff
    s_mov_b32 s14, s10
    s_mov_b32 s15, 0x20000
    s_mov_b32 s24, s70
    s_and_b32 s25, s71, 0xffff
    s_mov_b32 s26, 4718592
    s_mov_b32 s27, 0x20000
    s_mov_b32 s28, s68
    s_and_b32 s29, s69, 0xffff
    s_mov_b32 s30, 268435456
    s_mov_b32 s31, 0x20000
    s_mov_b32 s72, s60
    s_and_b32 s73, s61, 0xffff
    s_mov_b32 s74, 0
    s_mov_b32 s75, 0x20000
    s_lshl_b32 s49, 16384, s6
    s_lshl_b32 s46, 2048, s6
    s_mul_i32 s33, s46, s4
    s_add_u32 s50, s33, 98304
    s_lshl_b32 s46, s7, 3
    s_add_u32 s46, s46, s5
    s_lshl_b32 s87, s46, 19
    s_add_u32 s47, s6, 18
    s_lshl_b32 s32, s46, s47
    s_lshr_b32 s46, s4, 1
    s_lshl_b32 s46, s46, 17
    s_and_b32 s47, s4, 1
    s_lshl_b32 s48, s47, 12
    s_add_u32 s46, s46, s48
    s_add_u32 s87, s87, s46
    s_cmp_eq_u32 s6, 1
    s_cselect_b32 s46, s46, s33
    s_add_u32 s32, s32, s46
    s_lshl_b32 s47, s47, 3
    s_cmp_eq_u32 s6, 1
    s_cselect_b32 s47, 0, s47
    s_mov_b32 s34, 0
    v_lshlrev_b32 v6, 8, v2
    v_add_u32 v7, s47, v2
    v_add_u32 v1, 0, v7
    v_xor_b32 v1, v1, v3
    v_and_b32 v1, 15, v1
    v_lshl_add_u32 v8, v1, 4, v6
    v_add_u32 v1, 4, v7
    v_xor_b32 v1, v1, v3
    v_and_b32 v1, 15, v1
    v_lshl_add_u32 v9, v1, 4, v6
    v_add_u32 v1, 8, v7
    v_xor_b32 v1, v1, v3
    v_and_b32 v1, 15, v1
    v_lshl_add_u32 v10, v1, 4, v6
    v_add_u32 v1, 12, v7
    v_xor_b32 v1, v1, v3
    v_and_b32 v1, 15, v1
    v_lshl_add_u32 v11, v1, 4, v6
    v_lshlrev_b32 v1, 1, v2
    v_xor_b32 v1, v1, v3
    v_lshl_add_u32 v12, v1, 4, v6
    v_xor_b32 v13, 128, v12
    s_mov_b32 s54, 0
    s_lshl_b32 s46, s4, 11
    s_add_u32 s46, s46, 131072
    v_lshl_add_u32 v40, v0, 4, s46
    s_lshr_b32 s46, s4, 1
    s_mul_i32 s46, s46, s6
    s_lshl_b32 s46, s46, 13
    v_xor_b32 v7, v2, v3
    v_lshlrev_b32 v7, 4, v7
    v_lshl_add_u32 v7, v3, 8, v7
    v_add_u32 v24, s46, v7
    v_xor_b32 v25, 64, v24
    v_xor_b32 v26, 128, v24
    v_xor_b32 v27, 192, v24
    s_lshr_b32 s47, s49, 1
    s_add_u32 s46, s46, s47
    v_lshrrev_b32 v1, 2, v0
    v_and_b32 v6, 7, v1
    v_lshlrev_b32 v7, 8, v1
    v_lshl_add_u32 v7, v6, 5, v7
    v_and_b32 v1, 3, v0
    v_lshl_add_u32 v7, v1, 3, v7
    v_add_u32 v28, s46, v7
    v_xor_b32 v29, 32, v28
    v_xor_b32 v30, 64, v28
    v_xor_b32 v31, 96, v28
    v_xor_b32 v32, 128, v28
    v_xor_b32 v33, 160, v28
    v_xor_b32 v34, 192, v28
    v_xor_b32 v35, 224, v28
    s_mov_b32 s58, 0
    s_mov_b32 s59, 0
    s_mov_b32 s67, -65536
    s_mov_b32 s45, 3
    s_lshr_b32 s46, s4, 1
    s_lshl_b32 s46, s46, 14
    s_and_b32 s47, s4, 1
    s_lshl_b32 s47, s47, 12
    s_add_u32 s46, s46, s47
    s_add_u32 s46, s46, 131072
    v_lshrrev_b32 v6, 1, v3
    v_xor_b32 v6, v6, v2
    v_lshlrev_b32 v6, 4, v6
    v_lshl_add_u32 v6, v3, 7, v6
    v_add_u32 v38, s46, v6
    v_xor_b32 v39, 64, v38
    v_mov_b32 v220, 0
    v_mov_b32 v221, 0
    v_mov_b32 v222, 0
    v_mov_b32 v223, 0
    v_mov_b32 v224, 0
    v_mov_b32 v225, 0
    v_mov_b32 v226, 0
    v_mov_b32 v227, 0
    v_mov_b32 v228, 0
    v_mov_b32 v229, 0
    v_mov_b32 v230, 0
    v_mov_b32 v231, 0
    v_mov_b32 v232, 0
    v_mov_b32 v233, 0
    v_mov_b32 v234, 0
    v_mov_b32 v235, 0
    v_mov_b32 v236, 0
    v_mov_b32 v237, 0
    v_mov_b32 v238, 0
    v_mov_b32 v239, 0
    v_mov_b32 v240, 0
    v_mov_b32 v241, 0
    v_mov_b32 v242, 0
    v_mov_b32 v243, 0
    v_mov_b32 v69, 0
    v_mov_b32 v70, 0
    v_mov_b32 v71, 0
    v_mov_b32 v72, 0
    v_mov_b32 v73, 0
    v_mov_b32 v74, 0
    v_mov_b32 v75, 0
    v_mov_b32 v76, 0
    v_mov_b32 v77, 0
    v_mov_b32 v78, 0
    v_mov_b32 v79, 0
    v_mov_b32 v4, 0
    v_mov_b32 v16, 0
    v_mov_b32 v17, 0
    v_mov_b32 v18, 0
    v_mov_b32 v19, 0
    v_mov_b32 v20, 0
    v_mov_b32 v21, 0
    s_cmp_eq_u32 s6, 0
    s_cbranch_scc1 F_atset_ret
    v_mov_b32 v180, 0
    v_mov_b32 v181, 0
    v_mov_b32 v182, 0
    v_mov_b32 v183, 0
    v_mov_b32 v184, 0
    v_mov_b32 v185, 0
    v_mov_b32 v186, 0
    v_mov_b32 v187, 0
    v_mov_b32 v188, 0
    v_mov_b32 v189, 0
    v_mov_b32 v190, 0
    v_mov_b32 v191, 0
    v_mov_b32 v192, 0
    v_mov_b32 v193, 0
    v_mov_b32 v194, 0
    v_mov_b32 v195, 0
    v_mov_b32 v196, 0
    v_mov_b32 v197, 0
    v_mov_b32 v198, 0
    v_mov_b32 v199, 0
    v_mov_b32 v200, 0
    v_mov_b32 v201, 0
    v_mov_b32 v202, 0
    v_mov_b32 v203, 0
    v_mov_b32 v204, 0
    v_mov_b32 v205, 0
    v_mov_b32 v206, 0
    v_mov_b32 v207, 0
    v_mov_b32 v208, 0
    v_mov_b32 v209, 0
    v_mov_b32 v210, 0
    v_mov_b32 v211, 0
    v_mov_b32 v212, 0
    v_mov_b32 v213, 0
    v_mov_b32 v214, 0
    v_mov_b32 v215, 0
    v_mov_b32 v216, 0
    v_mov_b32 v217, 0
    v_mov_b32 v218, 0
    v_mov_b32 v219, 0
F_atset_ret:
    s_setpc_b64 s[64:65]
F_x:
    s_lshl_b32 s46, s39, 7
    s_add_u32 s46, s46, s38
    s_and_b32 s47, s40, 3
    s_lshl_b32 s47, s47, 2
    s_add_u32 s47, s47, s4
    s_lshl_b32 s47, s47, 11
    s_add_u32 m0, s47, 131072
    s_add_u32 s40, s40, 1
    s_add_u32 s39, s39, 1
    s_cmp_eq_u32 s39, 9
    s_cselect_b32 s39, 0, s39
    buffer_load_dwordx4 v14, s[16:19], s46 offen offset:0 lds
    buffer_load_dwordx4 v15, s[16:19], s46 offen offset:1024 lds
    s_setpc_b64 s[64:65]
F_w:
    s_lshl_b32 s46, s36, 19
    s_add_u32 s46, s46, s35
    s_mov_b32 m0, s51
    s_add_u32 s36, s36, 1
    buffer_load_dwordx4 v22, s[20:23], s46 offen offset:0 lds
    s_add_u32 s46, s46, 64512
    buffer_load_dwordx4 v23, s[20:23], s46 offen offset:1024 lds
    s_add_u32 s46, s46, 64512
    buffer_load_dwordx4 v22, s[20:23], s46 offen offset:2048 lds
    s_add_u32 s46, s46, 64512
    buffer_load_dwordx4 v23, s[20:23], s46 offen offset:3072 lds
    s_add_u32 m0, s51, 4096
    s_add_u32 s46, s46, 68608
    buffer_load_dwordx4 v22, s[20:23], s46 offen offset:0 lds
    s_add_u32 s46, s46, 64512
    buffer_load_dwordx4 v23, s[20:23], s46 offen offset:1024 lds
    s_add_u32 s46, s46, 64512
    buffer_load_dwordx4 v22, s[20:23], s46 offen offset:2048 lds
    s_add_u32 s46, s46, 64512
    buffer_load_dwordx4 v23, s[20:23], s46 offen offset:3072 lds
    s_cmp_eq_u32 s36, 9
    s_cselect_b32 s36, 0, s36
    s_add_u32 s37, s37, 1
    s_cmp_eq_u32 s37, 9
    s_cselect_b32 s47, 512, 0
    s_add_u32 s35, s35, s47
    s_setpc_b64 s[64:65]
F_kv:
    s_cmp_eq_u32 s6, 0
    s_cbranch_scc1 F_kv_a
    s_mov_b32 m0, s33
    s_cmp_eq_u32 s34, 15
    buffer_load_dwordx4 v8, s[8:11], s32 offen offset:0 nt lds
    s_cselect_b32 s55, 131072, 0
    s_add_u32 s55, s55, 8192
    s_add_u32 s34, s34, 1
    buffer_load_dwordx4 v9, s[8:11], s32 offen offset:1024 nt lds
    buffer_load_dwordx4 v10, s[8:11], s32 offen offset:2048 nt lds
    buffer_load_dwordx4 v11, s[8:11], s32 offen offset:3072 nt lds
    s_add_u32 m0, s33, 16384
    s_add_u32 s33, s33, 32768
    buffer_load_dwordx4 v12, s[12:15], s32 offen offset:0 nt lds
    buffer_load_dwordx4 v13, s[12:15], s32 offen offset:1024 nt lds
    buffer_load_dwordx4 v12, s[12:15], s32 offen offset:2048 nt lds
    buffer_load_dwordx4 v13, s[12:15], s32 offen offset:3072 nt lds
    s_add_u32 s32, s32, s55
    s_cmp_ge_u32 s33, s50
    s_cselect_b32 s55, 98304, 0
    s_sub_u32 s33, s33, s55
    s_mov_b32 s55, 8
    s_setpc_b64 s[64:65]
F_kv_a:
    s_mov_b32 s55, 0
    s_cmp_ge_u32 s34, 32
    s_cbranch_scc1 F_kv_ret
    s_mov_b32 m0, s33
    s_mov_b32 s55, 4
    buffer_load_dwordx4 v8, s[8:11], s32 offen offset:0 nt lds
    buffer_load_dwordx4 v9, s[8:11], s32 offen offset:1024 nt lds
    s_add_u32 m0, s33, 8192
    s_add_u32 s34, s34, 1
    buffer_load_dwordx4 v12, s[12:15], s32 offen offset:0 nt lds
    buffer_load_dwordx4 v13, s[12:15], s32 offen offset:1024 nt lds
    s_add_u32 s32, s32, 8192
    s_add_u32 s33, s33, 16384
    s_cmp_ge_u32 s33, s50
    s_cselect_b32 s46, 98304, 0
    s_sub_u32 s33, s33, s46
    s_cmp_eq_u32 s54, 0
    s_cbranch_scc1 F_kv_ret
    s_cmp_lt_u32 s34, 0
    s_cselect_b32 s85, 0, 4
    s_add_u32 s85, s34, s85
    s_min_u32 s85, s85, 31
    s_max_u32 s85, s85, 0
    s_and_b32 s46, s85, 15
    s_lshl_b32 s46, s46, 13
    s_lshr_b32 s47, s85, 4
    s_lshl_b32 s47, s47, 18
    s_add_u32 s46, s46, s47
    s_add_u32 s46, s46, s87
    v_lshlrev_b32 v1, 7, v0
    s_mov_b64 exec, 1048575
    buffer_load_dword v5, v1, s[72:75], s46 offen offset:1536
    s_mov_b64 exec, -1
F_kv_ret:
    s_setpc_b64 s[64:65]
F_wo:
    s_add_u32 s46, s41, s43
    s_and_b32 s46, s46, 3
    s_lshr_b32 s47, s41, 2
    s_lshl_b32 s47, s47, 2
    s_add_u32 s46, s46, s47
    s_mul_i32 s46, s46, 73728
    s_add_u32 s46, s46, s91
    s_add_u32 s47, s53, s52
    s_mov_b32 m0, s47
    s_add_u32 s46, s46, s42
    buffer_load_dwordx4 v16, s[24:27], s46 offen offset:0 lds
    buffer_load_dwordx4 v17, s[24:27], s46 offen offset:1024 lds
    buffer_load_dwordx4 v18, s[24:27], s46 offen offset:2048 lds
    buffer_load_dwordx4 v19, s[24:27], s46 offen offset:3072 lds
    s_add_u32 m0, s47, 4096
    s_nop 0
    buffer_load_dwordx4 v20, s[24:27], s46 offen offset:0 lds
    buffer_load_dwordx4 v21, s[24:27], s46 offen offset:1024 lds
    s_add_u32 s91, s91, 384
    s_cmp_eq_u32 s91, 1152
    s_cselect_b32 s91, 0, s91
    s_addc_u32 s41, s41, 0
    s_setpc_b64 s[64:65]
L_pj:
    s_mov_b32 s8, s58
    s_and_b32 s9, s59, 0xffff
    s_lshl_b32 s10, 33554432, s6
    s_mov_b32 s11, 0x20000
    s_mov_b32 s12, s60
    s_and_b32 s13, s61, 0xffff
    s_mov_b32 s14, s10
    s_mov_b32 s15, 0x20000
    s_mov_b32 s24, s70
    s_and_b32 s25, s71, 0xffff
    s_mov_b32 s26, 4718592
    s_mov_b32 s27, 0x20000
    s_mov_b32 s28, s68
    s_and_b32 s29, s69, 0xffff
    s_mov_b32 s30, 268435456
    s_mov_b32 s31, 0x20000
    s_mov_b32 s72, s60
    s_and_b32 s73, s61, 0xffff
    s_mov_b32 s74, 0
    s_mov_b32 s75, 0x20000
    v_mov_b32 v35, 0
    s_cmp_lg_u32 s4, 0
    s_cbranch_scc1 L_pj_a
    s_lshl_b32 s46, s6, 14
    s_lshl_b32 s47, s5, 7
    s_add_u32 s46, s46, s47
    s_add_u32 s46, s46, s88
    v_lshlrev_b32 v1, 4, v0
    v_mov_b32 v36, 0
    v_mov_b32 v37, 0
    v_mov_b32 v38, 0
    v_mov_b32 v39, 0
    s_mov_b64 exec, 0xff
    buffer_store_dwordx4 v[36:39], v1, s[28:31], s46 offen sc1
    s_mov_b64 exec, -1
L_pj_a:
    s_lshl_b32 s48, s4, 13
    s_mov_b32 s69, 32768
    s_mov_b32 s70, 65536
    s_mov_b32 s71, 98304
    v_lshrrev_b32 v1, 2, v3
    v_lshl_add_u32 v6, v2, 3, v1
    v_lshrrev_b32 v1, 1, v1
    v_and_b32 v7, 1, v2
    v_lshl_or_b32 v1, v7, 1, v1
    v_and_b32 v7, 3, v0
    v_lshlrev_b32 v7, 3, v7
    v_lshl_add_u32 v6, v6, 7, v7
    v_lshl_add_u32 v6, v1, 5, v6
    v_add_u32 v28, s48, v6
    v_add_u32 v24, 98304, v28
    v_xor_b32 v25, 32, v24
    v_xor_b32 v26, 64, v24
    v_xor_b32 v27, 96, v24
    v_lshrrev_b32 v1, 1, v3
    v_xor_b32 v6, v1, v2
    v_lshlrev_b32 v6, 4, v6
    v_lshl_add_u32 v6, v3, 7, v6
    v_add_u32 v31, 131072, v6
    v_xor_b32 v32, 64, v31
    v_mov_b32 v33, v31
    v_mov_b32 v34, v32
    v_lshrrev_b32 v6, 1, v2
    v_xor_b32 v6, v6, v1
    v_lshlrev_b32 v6, 4, v6
    v_lshl_add_u32 v6, v3, 7, v6
    v_and_b32 v7, 1, v2
    v_lshl_add_u32 v6, v7, 3, v6
    v_add_u32 v6, s48, v6
    v_add_u32 v29, 65536, v6
    v_mov_b32 v104, 0
    v_mov_b32 v105, 0
    v_mov_b32 v106, 0
    v_mov_b32 v107, 0
    v_mov_b32 v108, 0
    v_mov_b32 v109, 0
    v_mov_b32 v110, 0
    v_mov_b32 v111, 0
    v_mov_b32 v112, 0
    v_mov_b32 v113, 0
    v_mov_b32 v114, 0
    v_mov_b32 v115, 0
    v_mov_b32 v116, 0
    v_mov_b32 v117, 0
    v_mov_b32 v118, 0
    v_mov_b32 v119, 0
    v_mov_b32 v120, 0
    v_mov_b32 v121, 0
    v_mov_b32 v122, 0
    v_mov_b32 v123, 0
    v_mov_b32 v124, 0
    v_mov_b32 v125, 0
    v_mov_b32 v126, 0
    v_mov_b32 v127, 0
    v_mov_b32 v128, 0
    v_mov_b32 v129, 0
    v_mov_b32 v130, 0
    v_mov_b32 v131, 0
    v_mov_b32 v132, 0
    v_mov_b32 v133, 0
    v_mov_b32 v134, 0
    v_mov_b32 v135, 0
    v_mov_b32 v136, 0
    v_mov_b32 v137, 0
    v_mov_b32 v138, 0
    v_mov_b32 v139, 0
    v_mov_b32 v140, 0
    v_mov_b32 v141, 0
    v_mov_b32 v142, 0
    v_mov_b32 v143, 0
    v_mov_b32 v144, 0
    v_mov_b32 v145, 0
    v_mov_b32 v146, 0
    v_mov_b32 v147, 0
    v_mov_b32 v148, 0
    v_mov_b32 v149, 0
    v_mov_b32 v150, 0
    v_mov_b32 v151, 0
    v_mov_b32 v152, 0
    v_mov_b32 v153, 0
    v_mov_b32 v154, 0
    v_mov_b32 v155, 0
    v_mov_b32 v156, 0
    v_mov_b32 v157, 0
    v_mov_b32 v158, 0
    v_mov_b32 v159, 0
    v_mov_b32 v160, 0
    v_mov_b32 v161, 0
    v_mov_b32 v162, 0
    v_mov_b32 v163, 0
    v_mov_b32 v164, 0
    v_mov_b32 v165, 0
    v_mov_b32 v166, 0
    v_mov_b32 v167, 0
    v_mov_b32 v52, 0
    v_mov_b32 v88, 0
    v_mov_b32 v53, 0
    v_mov_b32 v89, 0
    v_mov_b32 v54, 0
    v_mov_b32 v90, 0
    v_mov_b32 v55, 0
    v_mov_b32 v91, 0
    v_mov_b32 v56, 0
    v_mov_b32 v92, 0
    v_mov_b32 v57, 0
    v_mov_b32 v93, 0
    v_mov_b32 v58, 0
    v_mov_b32 v94, 0
    v_mov_b32 v59, 0
    v_mov_b32 v95, 0
    v_mov_b32 v60, 0
    v_mov_b32 v96, 0
    v_mov_b32 v61, 0
    v_mov_b32 v97, 0
    v_mov_b32 v62, 0
    v_mov_b32 v98, 0
    v_mov_b32 v63, 0
    v_mov_b32 v99, 0
    v_mov_b32 v64, 0
    v_mov_b32 v100, 0
    v_mov_b32 v65, 0
    v_mov_b32 v101, 0
    v_mov_b32 v66, 0
    v_mov_b32 v102, 0
    v_mov_b32 v67, 0
    v_mov_b32 v103, 0
L_q0_setup:
    s_lshl_b32 s49, 16384, s6
    s_lshl_b32 s46, 2048, s6
    s_mul_i32 s33, s46, s4
    s_add_u32 s50, s33, 98304
    s_lshl_b32 s46, s7, 3
    s_add_u32 s46, s46, s5
    s_lshl_b32 s87, s46, 19
    s_add_u32 s47, s6, 18
    s_lshl_b32 s32, s46, s47
    s_lshr_b32 s46, s4, 1
    s_lshl_b32 s46, s46, 17
    s_and_b32 s47, s4, 1
    s_lshl_b32 s48, s47, 12
    s_add_u32 s46, s46, s48
    s_add_u32 s87, s87, s46
    s_cmp_eq_u32 s6, 1
    s_cselect_b32 s46, s46, s33
    s_add_u32 s32, s32, s46
    s_lshl_b32 s47, s47, 3
    s_cmp_eq_u32 s6, 1
    s_cselect_b32 s47, 0, s47
    s_mov_b32 s34, 0
    v_lshlrev_b32 v6, 8, v2
    v_add_u32 v7, s47, v2
    v_add_u32 v1, 0, v7
    v_xor_b32 v1, v1, v3
    v_and_b32 v1, 15, v1
    v_lshl_add_u32 v8, v1, 4, v6
    v_add_u32 v1, 4, v7
    v_xor_b32 v1, v1, v3
    v_and_b32 v1, 15, v1
    v_lshl_add_u32 v9, v1, 4, v6
    v_add_u32 v1, 8, v7
    v_xor_b32 v1, v1, v3
    v_and_b32 v1, 15, v1
    v_lshl_add_u32 v10, v1, 4, v6
    v_add_u32 v1, 12, v7
    v_xor_b32 v1, v1, v3
    v_and_b32 v1, 15, v1
    v_lshl_add_u32 v11, v1, 4, v6
    v_lshlrev_b32 v1, 1, v2
    v_xor_b32 v1, v1, v3
    v_lshl_add_u32 v12, v1, 4, v6
    v_xor_b32 v13, 128, v12
    v_add_u32 v1, 0, v0
    v_mul_u32_u24 v6, 2731, v1
    v_lshrrev_b32 v6, 16, v6
    v_mul_u32_u24 v7, 24, v6
    v_sub_u32 v1, v1, v7
    v_and_b32 v7, 6, v6
    v_xor_b32 v1, v1, v7
    v_lshlrev_b32 v1, 4, v1
    v_mul_u32_u24 v6, 1152, v6
    v_add_u32 v1, v1, v6
    v_subrev_u32 v16, 0, v1
    v_add_u32 v1, 64, v0
    v_mul_u32_u24 v6, 2731, v1
    v_lshrrev_b32 v6, 16, v6
    v_mul_u32_u24 v7, 24, v6
    v_sub_u32 v1, v1, v7
    v_and_b32 v7, 6, v6
    v_xor_b32 v1, v1, v7
    v_lshlrev_b32 v1, 4, v1
    v_mul_u32_u24 v6, 1152, v6
    v_add_u32 v1, v1, v6
    v_subrev_u32 v17, 1024, v1
    v_add_u32 v1, 128, v0
    v_mul_u32_u24 v6, 2731, v1
    v_lshrrev_b32 v6, 16, v6
    v_mul_u32_u24 v7, 24, v6
    v_sub_u32 v1, v1, v7
    v_and_b32 v7, 6, v6
    v_xor_b32 v1, v1, v7
    v_lshlrev_b32 v1, 4, v1
    v_mul_u32_u24 v6, 1152, v6
    v_add_u32 v1, v1, v6
    v_subrev_u32 v18, 2048, v1
    v_add_u32 v1, 192, v0
    v_mul_u32_u24 v6, 2731, v1
    v_lshrrev_b32 v6, 16, v6
    v_mul_u32_u24 v7, 24, v6
    v_sub_u32 v1, v1, v7
    v_and_b32 v7, 6, v6
    v_xor_b32 v1, v1, v7
    v_lshlrev_b32 v1, 4, v1
    v_mul_u32_u24 v6, 1152, v6
    v_add_u32 v1, v1, v6
    v_subrev_u32 v19, 3072, v1
    v_add_u32 v1, 256, v0
    v_mul_u32_u24 v6, 2731, v1
    v_lshrrev_b32 v6, 16, v6
    v_mul_u32_u24 v7, 24, v6
    v_sub_u32 v1, v1, v7
    v_and_b32 v7, 6, v6
    v_xor_b32 v1, v1, v7
    v_lshlrev_b32 v1, 4, v1
    v_mul_u32_u24 v6, 1152, v6
    v_add_u32 v1, v1, v6
    v_subrev_u32 v20, 0, v1
    v_add_u32 v1, 320, v0
    v_mul_u32_u24 v6, 2731, v1
    v_lshrrev_b32 v6, 16, v6
    v_mul_u32_u24 v7, 24, v6
    v_sub_u32 v1, v1, v7
    v_and_b32 v7, 6, v6
    v_xor_b32 v1, v1, v7
    v_lshlrev_b32 v1, 4, v1
    v_mul_u32_u24 v6, 1152, v6
    v_add_u32 v1, v1, v6
    v_subrev_u32 v21, 1024, v1
    s_lshl_b32 s46, s5, 9
    s_lshl_b32 s47, s4, 4
    s_add_u32 s46, s46, s47
    s_mul_i32 s42, s46, 1152
    s_and_b32 s43, s7, 3
    s_mul_i32 s52, s4, 6144
    s_cmp_eq_u32 s6, 1
    s_mov_b32 s60, 98304
    s_mov_b32 s61, 65536
    s_cselect_b32 s62, 0, 32768
    s_cselect_b32 s63, 32768, 0
    s_cmp_eq_u32 s6, 1
    s_cselect_b32 s34, 2, 2
    s_lshl_b32 s46, s34, 13
    s_add_u32 s32, s32, s46
    s_mul_i32 s46, s34, s49
    s_add_u32 s33, s33, s46
    s_mov_b32 s54, 1
    s_add_u32 s35, s35, 512
    s_add_u32 s36, s36, 7
    s_sub_u32 s46, s36, 9
    s_cselect_b32 s36, s36, s46
    s_lshl_b32 s48, s4, 13
    s_add_u32 s51, s48, 98304
    s_mov_b32 s40, 4
    s_add_u32 s39, s39, 4
    s_sub_u32 s46, s39, 9
    s_cselect_b32 s39, s39, s46
    s_mov_b32 s41, 0
    s_mov_b32 s91, 0
    s_mov_b32 s53, 98304
    s_mov_b32 s84, 0
    s_mov_b32 s85, 2
    v_mov_b32 v4, 0
    v_mov_b32 v168, 0
    v_mov_b32 v169, 0
    v_mov_b32 v170, 0
    v_mov_b32 v171, 0
    v_mov_b32 v172, 0
    v_mov_b32 v173, 0
    v_mov_b32 v174, 0
    v_mov_b32 v175, 0
    v_mov_b32 v176, 0
    v_mov_b32 v177, 0
    v_mov_b32 v178, 0
    v_mov_b32 v179, 0
    v_mov_b32 v180, 0
    v_mov_b32 v181, 0
    v_mov_b32 v182, 0
    v_mov_b32 v183, 0
    v_mov_b32 v184, 0
    v_mov_b32 v185, 0
    v_mov_b32 v186, 0
    v_mov_b32 v187, 0
    v_mov_b32 v188, 0
    v_mov_b32 v189, 0
    v_mov_b32 v190, 0
    v_mov_b32 v191, 0
    v_mov_b32 v192, 0
    v_mov_b32 v193, 0
    v_mov_b32 v194, 0
    v_mov_b32 v195, 0
    v_mov_b32 v196, 0
    v_mov_b32 v197, 0
    v_mov_b32 v198, 0
    v_mov_b32 v199, 0
    v_mov_b32 v200, 0
    v_mov_b32 v201, 0
    v_mov_b32 v202, 0
    v_mov_b32 v203, 0
    v_mov_b32 v204, 0
    v_mov_b32 v205, 0
    v_mov_b32 v206, 0
    v_mov_b32 v207, 0
    v_mov_b32 v208, 0
    v_mov_b32 v209, 0
    v_mov_b32 v210, 0
    v_mov_b32 v211, 0
    v_mov_b32 v212, 0
    v_mov_b32 v213, 0
    v_mov_b32 v214, 0
    v_mov_b32 v215, 0
    v_mov_b32 v216, 0
    v_mov_b32 v217, 0
    v_mov_b32 v218, 0
    v_mov_b32 v219, 0
    v_mov_b32 v220, 0
    v_mov_b32 v221, 0
    v_mov_b32 v222, 0
    v_mov_b32 v223, 0
    v_mov_b32 v224, 0
    v_mov_b32 v225, 0
    v_mov_b32 v226, 0
    v_mov_b32 v227, 0
    v_mov_b32 v228, 0
    v_mov_b32 v229, 0
    v_mov_b32 v230, 0
    v_mov_b32 v231, 0
    s_mov_b32 s76, s82
    s_and_b32 s77, s83, 0xffff
    s_mov_b32 s78, 256
    s_mov_b32 s79, 0x20000
    v_mov_b32 v1, 1
    s_lshl_b32 s46, s7, 2
    s_mov_b32 s44, 0
    s_waitcnt vmcnt(0)
    s_cmp_lg_u32 s4, 0
    s_cbranch_scc1 L_q0
    s_mov_b64 exec, 1
    buffer_atomic_add v1, v35, s[76:79], s46 offen offset:0 sc1
    s_mov_b64 exec, -1
L_q0:
    s_barrier
    ds_read_b128 v[72:75], v33 offset:0
    ds_read_b64_tr_b16 v[36:37], v24 offset:0
    v_mfma_f32_16x16x32_bf16 v[104:107], v[52:55], v[88:91], v[104:107]
    ds_read_b64_tr_b16 v[38:39], v24 offset:512
    ds_read_b128 v[76:79], v33 offset:2048
    v_mfma_f32_16x16x32_bf16 v[108:111], v[52:55], v[92:95], v[108:111]
    ds_read_b128 v[80:83], v33 offset:4096
    ds_read_b128 v[84:87], v33 offset:6144
    v_mfma_f32_16x16x32_bf16 v[112:115], v[52:55], v[96:99], v[112:115]
    ds_read_b64_tr_b16 v[40:41], v25 offset:0
    ds_read_b64_tr_b16 v[42:43], v25 offset:512
    v_mfma_f32_16x16x32_bf16 v[116:119], v[52:55], v[100:103], v[116:119]
    ds_read_b64_tr_b16 v[44:45], v26 offset:0
    ds_read_b64_tr_b16 v[46:47], v26 offset:512
    v_mfma_f32_16x16x32_bf16 v[120:123], v[56:59], v[88:91], v[120:123]
    ds_read_b64_tr_b16 v[48:49], v27 offset:0
    ds_read_b64_tr_b16 v[50:51], v27 offset:512
    v_mfma_f32_16x16x32_bf16 v[124:127], v[56:59], v[92:95], v[124:127]
    v_mfma_f32_16x16x32_bf16 v[128:131], v[56:59], v[96:99], v[128:131]
    ds_read_b64_tr_b16 v[52:53], v24 offset:4096
    v_mfma_f32_16x16x32_bf16 v[132:135], v[56:59], v[100:103], v[132:135]
    ds_read_b64_tr_b16 v[54:55], v24 offset:4608
    v_mfma_f32_16x16x32_bf16 v[136:139], v[60:63], v[88:91], v[136:139]
    ds_read_b64_tr_b16 v[56:57], v25 offset:4096
    v_mfma_f32_16x16x32_bf16 v[140:143], v[60:63], v[92:95], v[140:143]
    s_waitcnt lgkmcnt(14)
    ds_read_b64_tr_b16 v[58:59], v25 offset:4608
    v_mfma_f32_16x16x32_bf16 v[144:147], v[60:63], v[96:99], v[144:147]
    v_mfma_f32_16x16x32_bf16 v[148:151], v[60:63], v[100:103], v[148:151]
    v_mfma_f32_16x16x32_bf16 v[152:155], v[64:67], v[88:91], v[152:155]
    s_waitcnt lgkmcnt(14)
    ds_read_b64_tr_b16 v[60:61], v26 offset:4096
    v_mfma_f32_16x16x32_bf16 v[156:159], v[64:67], v[92:95], v[156:159]
    s_waitcnt lgkmcnt(14)
    ds_read_b64_tr_b16 v[62:63], v26 offset:4608
    v_mfma_f32_16x16x32_bf16 v[160:163], v[64:67], v[96:99], v[160:163]
    v_mfma_f32_16x16x32_bf16 v[164:167], v[64:67], v[100:103], v[164:167]
    s_waitcnt lgkmcnt(6)
    v_mfma_f32_16x16x32_bf16 v[104:107], v[36:39], v[72:75], v[104:107]
    ds_read_b64_tr_b16 v[64:65], v27 offset:4096
    v_mfma_f32_16x16x32_bf16 v[108:111], v[36:39], v[76:79], v[108:111]
    ds_read_b64_tr_b16 v[66:67], v27 offset:4608
    v_mfma_f32_16x16x32_bf16 v[112:115], v[36:39], v[80:83], v[112:115]
    ds_read_b128 v[88:91], v34 offset:0
    v_mfma_f32_16x16x32_bf16 v[116:119], v[36:39], v[84:87], v[116:119]
    ds_read_b128 v[92:95], v34 offset:2048
    v_mfma_f32_16x16x32_bf16 v[120:123], v[40:43], v[72:75], v[120:123]
    ds_read_b128 v[96:99], v34 offset:4096
    v_mfma_f32_16x16x32_bf16 v[124:127], v[40:43], v[76:79], v[124:127]
    ds_read_b128 v[100:103], v34 offset:6144
    v_mfma_f32_16x16x32_bf16 v[128:131], v[40:43], v[80:83], v[128:131]
    v_add_u32 v24, s69, v28
    s_mov_b32 s46, s69
    v_mfma_f32_16x16x32_bf16 v[132:135], v[40:43], v[84:87], v[132:135]
    v_xor_b32 v25, 32, v24
    s_mov_b32 s69, s70
    v_mfma_f32_16x16x32_bf16 v[136:139], v[44:47], v[72:75], v[136:139]
    v_xor_b32 v26, 64, v24
    s_mov_b32 s70, s71
    v_mfma_f32_16x16x32_bf16 v[140:143], v[44:47], v[76:79], v[140:143]
    v_xor_b32 v27, 96, v24
    s_mov_b32 s71, s46
    v_mfma_f32_16x16x32_bf16 v[144:147], v[44:47], v[80:83], v[144:147]
    s_add_u32 s44, s44, 1
    s_and_b32 s46, s44, 3
    s_lshl_b32 s46, s46, 13
    v_mfma_f32_16x16x32_bf16 v[148:151], v[44:47], v[84:87], v[148:151]
    v_add_u32 v33, s46, v31
    v_mfma_f32_16x16x32_bf16 v[152:155], v[48:51], v[72:75], v[152:155]
    v_add_u32 v34, s46, v32
    v_mfma_f32_16x16x32_bf16 v[156:159], v[48:51], v[76:79], v[156:159]
    v_mfma_f32_16x16x32_bf16 v[160:163], v[48:51], v[80:83], v[160:163]
    s_waitcnt lgkmcnt(0)
    s_cmp_lt_u32 s44, 9
    v_mfma_f32_16x16x32_bf16 v[164:167], v[48:51], v[84:87], v[164:167]
    s_cbranch_scc1 L_q0
    s_mov_b32 s48, 0x3e0293ee
    v_mfma_f32_16x16x32_bf16 v[104:107], v[52:55], v[88:91], v[104:107]
    v_mfma_f32_16x16x32_bf16 v[108:111], v[52:55], v[92:95], v[108:111]
    v_mfma_f32_16x16x32_bf16 v[112:115], v[52:55], v[96:99], v[112:115]
    v_mfma_f32_16x16x32_bf16 v[116:119], v[52:55], v[100:103], v[116:119]
    v_mfma_f32_16x16x32_bf16 v[120:123], v[56:59], v[88:91], v[120:123]
    s_nop 3
    v_mul_f32 v104, s48, v104
    v_mul_f32 v105, s48, v105
    v_mul_f32 v106, s48, v106
    v_mul_f32 v107, s48, v107
    v_mfma_f32_16x16x32_bf16 v[124:127], v[56:59], v[92:95], v[124:127]
    v_cvt_pk_bf16_f32 v104, v104, v105
    v_cvt_pk_bf16_f32 v105, v106, v107
    v_mul_f32 v108, s48, v108
    v_mul_f32 v109, s48, v109
    v_mul_f32 v110, s48, v110
    v_mul_f32 v111, s48, v111
    v_mfma_f32_16x16x32_bf16 v[128:131], v[56:59], v[96:99], v[128:131]
    v_xor_b32 v1, 0, v29
    ds_write_b64 v1, v[104:105] offset:0
    v_cvt_pk_bf16_f32 v108, v108, v109
    v_cvt_pk_bf16_f32 v109, v110, v111
    v_mul_f32 v112, s48, v112
    v_mul_f32 v113, s48, v113
    v_mul_f32 v114, s48, v114
    v_mul_f32 v115, s48, v115
    v_mfma_f32_16x16x32_bf16 v[132:135], v[56:59], v[100:103], v[132:135]
    ds_write_b64 v1, v[108:109] offset:2048
    v_cvt_pk_bf16_f32 v112, v112, v113
    v_cvt_pk_bf16_f32 v113, v114, v115
    v_mul_f32 v116, s48, v116
    v_mul_f32 v117, s48, v117
    v_mul_f32 v118, s48, v118
    v_mul_f32 v119, s48, v119
    v_mfma_f32_16x16x32_bf16 v[136:139], v[60:63], v[88:91], v[136:139]
    ds_write_b64 v1, v[112:113] offset:4096
    v_cvt_pk_bf16_f32 v116, v116, v117
    v_cvt_pk_bf16_f32 v117, v118, v119
    v_mul_f32 v120, s48, v120
    v_mul_f32 v121, s48, v121
    v_mul_f32 v122, s48, v122
    v_mul_f32 v123, s48, v123
    v_mfma_f32_16x16x32_bf16 v[140:143], v[60:63], v[92:95], v[140:143]
    ds_write_b64 v1, v[116:117] offset:6144
    v_cvt_pk_bf16_f32 v120, v120, v121
    v_cvt_pk_bf16_f32 v121, v122, v123
    v_mul_f32 v124, s48, v124
    v_mul_f32 v125, s48, v125
    v_mul_f32 v126, s48, v126
    v_mul_f32 v127, s48, v127
    v_mfma_f32_16x16x32_bf16 v[144:147], v[60:63], v[96:99], v[144:147]
    v_xor_b32 v1, 32, v29
    ds_write_b64 v1, v[120:121] offset:0
    v_cvt_pk_bf16_f32 v124, v124, v125
    v_cvt_pk_bf16_f32 v125, v126, v127
    v_mul_f32 v128, s48, v128
    v_mul_f32 v129, s48, v129
    v_mul_f32 v130, s48, v130
    v_mul_f32 v131, s48, v131
    v_mfma_f32_16x16x32_bf16 v[148:151], v[60:63], v[100:103], v[148:151]
    ds_write_b64 v1, v[124:125] offset:2048
    v_cvt_pk_bf16_f32 v128, v128, v129
    v_cvt_pk_bf16_f32 v129, v130, v131
    v_mul_f32 v132, s48, v132
    v_mul_f32 v133, s48, v133
    v_mul_f32 v134, s48, v134
    v_mul_f32 v135, s48, v135
    v_mfma_f32_16x16x32_bf16 v[152:155], v[64:67], v[88:91], v[152:155]
    ds_write_b64 v1, v[128:129] offset:4096
    v_cvt_pk_bf16_f32 v132, v132, v133
    v_cvt_pk_bf16_f32 v133, v134, v135
    v_mul_f32 v136, s48, v136
    v_mul_f32 v137, s48, v137
    v_mul_f32 v138, s48, v138
    v_mul_f32 v139, s48, v139
    v_mfma_f32_16x16x32_bf16 v[156:159], v[64:67], v[92:95], v[156:159]
    ds_write_b64 v1, v[132:133] offset:6144
    v_cvt_pk_bf16_f32 v136, v136, v137
    v_cvt_pk_bf16_f32 v137, v138, v139
    v_mul_f32 v140, s48, v140
    v_mul_f32 v141, s48, v141
    v_mul_f32 v142, s48, v142
    v_mul_f32 v143, s48, v143
    v_mfma_f32_16x16x32_bf16 v[160:163], v[64:67], v[96:99], v[160:163]
    v_xor_b32 v1, 64, v29
    ds_write_b64 v1, v[136:137] offset:0
    v_cvt_pk_bf16_f32 v140, v140, v141
    v_cvt_pk_bf16_f32 v141, v142, v143
    v_mul_f32 v144, s48, v144
    v_mul_f32 v145, s48, v145
    v_mul_f32 v146, s48, v146
    v_mul_f32 v147, s48, v147
    v_mfma_f32_16x16x32_bf16 v[164:167], v[64:67], v[100:103], v[164:167]
    ds_write_b64 v1, v[140:141] offset:2048
    v_cvt_pk_bf16_f32 v144, v144, v145
    v_cvt_pk_bf16_f32 v145, v146, v147
    v_mul_f32 v148, s48, v148
    v_mul_f32 v149, s48, v149
    v_mul_f32 v150, s48, v150
    v_mul_f32 v151, s48, v151
    ds_write_b64 v1, v[144:145] offset:4096
    v_cvt_pk_bf16_f32 v148, v148, v149
    v_cvt_pk_bf16_f32 v149, v150, v151
    v_mul_f32 v152, s48, v152
    v_mul_f32 v153, s48, v153
    v_mul_f32 v154, s48, v154
    v_mul_f32 v155, s48, v155
    ds_write_b64 v1, v[148:149] offset:6144
    v_cvt_pk_bf16_f32 v152, v152, v153
    v_cvt_pk_bf16_f32 v153, v154, v155
    v_mul_f32 v156, s48, v156
    v_mul_f32 v157, s48, v157
    v_mul_f32 v158, s48, v158
    v_mul_f32 v159, s48, v159
    v_xor_b32 v1, 96, v29
    ds_write_b64 v1, v[152:153] offset:0
    v_cvt_pk_bf16_f32 v156, v156, v157
    v_cvt_pk_bf16_f32 v157, v158, v159
    v_mul_f32 v160, s48, v160
    v_mul_f32 v161, s48, v161
    v_mul_f32 v162, s48, v162
    v_mul_f32 v163, s48, v163
    ds_write_b64 v1, v[156:157] offset:2048
    v_cvt_pk_bf16_f32 v160, v160, v161
    v_cvt_pk_bf16_f32 v161, v162, v163
    v_mul_f32 v164, s48, v164
    v_mul_f32 v165, s48, v165
    v_mul_f32 v166, s48, v166
    v_mul_f32 v167, s48, v167
    ds_write_b64 v1, v[160:161] offset:4096
    v_cvt_pk_bf16_f32 v164, v164, v165
    v_cvt_pk_bf16_f32 v165, v166, v167
    ds_write_b64 v1, v[164:165] offset:6144
    s_waitcnt lgkmcnt(0)
    v_xor_b32 v29, 32768, v29
    s_branch L_pj_rest
L_stage:
    s_mov_b32 s56, 0xff7fffff
    s_mov_b32 s57, 0xff7fffff
    s_mov_b32 s66, 0
    s_cmp_lg_u32 s59, 0
    s_cbranch_scc1 L_stage_a
    v_mov_b32 v68, 0
L_stage_a:
    v_add_u32 v40, s67, v38
    v_add_u32 v41, s67, v39
    s_mov_b32 s44, 0
L_tile:
    s_barrier
    s_cmp_lg_u32 s44, 0
    s_cbranch_scc1 L_tile_k
    ds_read_b128 v[84:87], v40 offset:0
    ds_read_b128 v[88:91], v41 offset:0
    ds_read_b128 v[92:95], v40 offset:8192
    ds_read_b128 v[96:99], v41 offset:8192
    ds_read_b128 v[100:103], v40 offset:2048
    ds_read_b128 v[104:107], v41 offset:2048
    ds_read_b128 v[108:111], v40 offset:10240
    ds_read_b128 v[112:115], v41 offset:10240
    s_waitcnt lgkmcnt(0)
L_tile_k:
    ds_read_b128 v[116:119], v24 offset:0
    ds_read_b128 v[120:123], v24 offset:4096
    ds_read_b128 v[124:127], v25 offset:0
    ds_read_b128 v[128:131], v25 offset:4096
    ds_read_b128 v[132:135], v26 offset:0
    ds_read_b128 v[136:139], v26 offset:4096
    ds_read_b128 v[140:143], v27 offset:0
    ds_read_b128 v[144:147], v27 offset:4096
    s_barrier
    s_waitcnt lgkmcnt(7)
    v_mfma_f32_16x16x32_bf16 v[52:55], v[116:119], v[84:87], v[68:71]
    ds_read_b64_tr_b16 v[148:149], v28 offset:0
    v_mfma_f32_16x16x32_bf16 v[60:63], v[116:119], v[100:103], v[72:75]
    ds_read_b64_tr_b16 v[150:151], v28 offset:4096
    s_waitcnt lgkmcnt(8)
    v_mfma_f32_16x16x32_bf16 v[56:59], v[120:123], v[84:87], v[68:71]
    ds_read_b64_tr_b16 v[152:153], v29 offset:0
    v_mfma_f32_16x16x32_bf16 v[64:67], v[120:123], v[100:103], v[72:75]
    ds_read_b64_tr_b16 v[154:155], v29 offset:4096
    s_waitcnt lgkmcnt(9)
    v_mfma_f32_16x16x32_bf16 v[52:55], v[124:127], v[88:91], v[52:55]
    ds_read_b64_tr_b16 v[156:157], v30 offset:0
    v_mfma_f32_16x16x32_bf16 v[60:63], v[124:127], v[104:107], v[60:63]
    ds_read_b64_tr_b16 v[158:159], v30 offset:4096
    s_waitcnt lgkmcnt(10)
    v_mfma_f32_16x16x32_bf16 v[56:59], v[128:131], v[88:91], v[56:59]
    ds_read_b64_tr_b16 v[160:161], v31 offset:0
    v_mfma_f32_16x16x32_bf16 v[64:67], v[128:131], v[104:107], v[64:67]
    ds_read_b64_tr_b16 v[162:163], v31 offset:4096
    s_waitcnt lgkmcnt(11)
    v_mfma_f32_16x16x32_bf16 v[52:55], v[132:135], v[92:95], v[52:55]
    ds_read_b64_tr_b16 v[164:165], v32 offset:0
    v_mfma_f32_16x16x32_bf16 v[60:63], v[132:135], v[108:111], v[60:63]
    ds_read_b64_tr_b16 v[166:167], v32 offset:4096
    s_waitcnt lgkmcnt(12)
    v_mfma_f32_16x16x32_bf16 v[56:59], v[136:139], v[92:95], v[56:59]
    ds_read_b64_tr_b16 v[168:169], v33 offset:0
    v_mfma_f32_16x16x32_bf16 v[64:67], v[136:139], v[108:111], v[64:67]
    ds_read_b64_tr_b16 v[170:171], v33 offset:4096
    s_waitcnt lgkmcnt(13)
    v_mfma_f32_16x16x32_bf16 v[52:55], v[140:143], v[96:99], v[52:55]
    ds_read_b64_tr_b16 v[172:173], v34 offset:0
    v_mfma_f32_16x16x32_bf16 v[60:63], v[140:143], v[112:115], v[60:63]
    ds_read_b64_tr_b16 v[174:175], v34 offset:4096
    s_waitcnt lgkmcnt(14)
    v_mfma_f32_16x16x32_bf16 v[56:59], v[144:147], v[96:99], v[56:59]
    ds_read_b64_tr_b16 v[176:177], v35 offset:0
    v_mfma_f32_16x16x32_bf16 v[64:67], v[144:147], v[112:115], v[64:67]
    s_waitcnt lgkmcnt(14)
    ds_read_b64_tr_b16 v[178:179], v35 offset:4096
    s_add_u32 s58, s58, s49
    s_cmp_ge_u32 s58, 98304
    s_cselect_b32 s46, 98304, 0
    s_sub_u32 s58, s58, s46
    s_sub_u32 s90, s49, s46
    v_add_u32 v24, s90, v24
    v_add_u32 v25, s90, v25
    v_max3_f32 v40, v52, v53, v54
    v_max3_f32 v40, v40, v55, v56
    v_max3_f32 v41, v60, v61, v62
    v_max3_f32 v40, v40, v57, v58
    v_max3_f32 v41, v41, v63, v64
    v_max_f32 v40, v40, v59
    v_max3_f32 v41, v41, v65, v66
    v_max_f32 v41, v41, v67
    v_max_f32 v42, v40, v41
    v_cmp_lt_f32 vcc, s56, v42
    s_cbranch_vccnz L_rescale
L_tile_exp:
    v_exp_f32 v52, v52
    v_exp_f32 v53, v53
    v_exp_f32 v54, v54
    v_exp_f32 v55, v55
    v_cvt_pk_bf16_f32 v44, v52, v53
    v_exp_f32 v56, v56
    v_exp_f32 v57, v57
    v_cvt_pk_bf16_f32 v45, v54, v55
    v_exp_f32 v58, v58
    v_exp_f32 v59, v59
    v_cvt_pk_bf16_f32 v46, v56, v57
    v_exp_f32 v60, v60
    v_cvt_pk_bf16_f32 v47, v58, v59
    v_exp_f32 v61, v61
    v_pk_add_f32 v[76:77], v[76:77], v[52:53]
    s_waitcnt lgkmcnt(12)
    v_mfma_f32_16x16x32_bf16 v[180:183], v[148:151], v[44:47], v[180:183]
    v_exp_f32 v62, v62
    v_mfma_f32_16x16x32_bf16 v[184:187], v[152:155], v[44:47], v[184:187]
    v_exp_f32 v63, v63
    v_cvt_pk_bf16_f32 v48, v60, v61
    s_waitcnt lgkmcnt(8)
    v_mfma_f32_16x16x32_bf16 v[196:199], v[156:159], v[44:47], v[196:199]
    v_exp_f32 v64, v64
    v_mfma_f32_16x16x32_bf16 v[200:203], v[160:163], v[44:47], v[200:203]
    v_exp_f32 v65, v65
    v_cvt_pk_bf16_f32 v49, v62, v63
    s_waitcnt lgkmcnt(4)
    v_mfma_f32_16x16x32_bf16 v[212:215], v[164:167], v[44:47], v[212:215]
    v_exp_f32 v66, v66
    v_mfma_f32_16x16x32_bf16 v[216:219], v[168:171], v[44:47], v[216:219]
    v_exp_f32 v67, v67
    s_waitcnt lgkmcnt(0)
    v_mfma_f32_16x16x32_bf16 v[228:231], v[172:175], v[44:47], v[228:231]
    v_cvt_pk_bf16_f32 v50, v64, v65
    v_mfma_f32_16x16x32_bf16 v[232:235], v[176:179], v[44:47], v[232:235]
    v_cvt_pk_bf16_f32 v51, v66, v67
    v_pk_add_f32 v[76:77], v[76:77], v[54:55]
    s_nop 0
    s_cmp_eq_u32 s44, 15
    s_cbranch_scc1 L_tile_last
    v_mfma_f32_16x16x32_bf16 v[188:191], v[148:151], v[48:51], v[188:191]
    v_pk_add_f32 v[78:79], v[78:79], v[60:61]
    v_pk_add_f32 v[76:77], v[76:77], v[56:57]
    v_mfma_f32_16x16x32_bf16 v[192:195], v[152:155], v[48:51], v[192:195]
    v_pk_add_f32 v[78:79], v[78:79], v[62:63]
    v_pk_add_f32 v[76:77], v[76:77], v[58:59]
    v_mfma_f32_16x16x32_bf16 v[204:207], v[156:159], v[48:51], v[204:207]
    v_pk_add_f32 v[78:79], v[78:79], v[64:65]
    v_mfma_f32_16x16x32_bf16 v[208:211], v[160:163], v[48:51], v[208:211]
    v_add_u32 v26, s90, v26
    v_add_u32 v27, s90, v27
    v_mfma_f32_16x16x32_bf16 v[220:223], v[164:167], v[48:51], v[220:223]
    v_pk_add_f32 v[78:79], v[78:79], v[66:67]
    v_add_u32 v28, s90, v28
    v_mfma_f32_16x16x32_bf16 v[224:227], v[168:171], v[48:51], v[224:227]
    v_add_u32 v29, s90, v29
    v_add_u32 v30, s90, v30
    v_add_u32 v31, s90, v31
    v_mfma_f32_16x16x32_bf16 v[236:239], v[172:175], v[48:51], v[236:239]
    v_add_u32 v32, s90, v32
    v_add_u32 v33, s90, v33
    v_add_u32 v34, s90, v34
    v_mfma_f32_16x16x32_bf16 v[240:243], v[176:179], v[48:51], v[240:243]
    v_add_u32 v35, s90, v35
    s_or_b32 s46, s59, s44
    s_cbranch_scc1 L_tile_nw
    s_waitcnt vmcnt(0)
L_tile_nw:
    s_add_u32 s44, s44, 1
    s_branch L_tile
L_tile_last:
    v_mfma_f32_16x16x32_bf16 v[188:191], v[148:151], v[48:51], v[188:191]
    v_pk_add_f32 v[76:77], v[76:77], v[56:57]
    v_pk_add_f32 v[78:79], v[78:79], v[60:61]
    v_pk_add_f32 v[76:77], v[76:77], v[58:59]
    v_mfma_f32_16x16x32_bf16 v[192:195], v[152:155], v[48:51], v[192:195]
    v_pk_add_f32 v[78:79], v[78:79], v[62:63]
    v_pk_add_f32 v[78:79], v[78:79], v[64:65]
    v_pk_add_f32 v[78:79], v[78:79], v[66:67]
    v_mfma_f32_16x16x32_bf16 v[204:207], v[156:159], v[48:51], v[204:207]
    v_add_f32 v76, v76, v77
    v_add_f32 v77, v78, v79
    v_mov_b32 v78, v76
    v_mfma_f32_16x16x32_bf16 v[208:211], v[160:163], v[48:51], v[208:211]
    v_mov_b32 v79, v77
    s_mov_b32 s67, -32768
    s_add_u32 s59, s59, 1
    v_mfma_f32_16x16x32_bf16 v[220:223], v[164:167], v[48:51], v[220:223]
    v_permlane32_swap_b32 v76, v78
    v_permlane32_swap_b32 v77, v79
    v_add_f32 v76, v76, v78
    v_mfma_f32_16x16x32_bf16 v[224:227], v[168:171], v[48:51], v[224:227]
    v_add_f32 v77, v77, v79
    v_mov_b32 v78, v76
    v_mov_b32 v79, v77
    v_mfma_f32_16x16x32_bf16 v[236:239], v[172:175], v[48:51], v[236:239]
    s_nop 1
    v_permlane16_swap_b32 v76, v78
    v_permlane16_swap_b32 v77, v79
    v_mfma_f32_16x16x32_bf16 v[240:243], v[176:179], v[48:51], v[240:243]
    v_add_f32 v42, v76, v78
    v_add_f32 v40, v77, v79
    v_rcp_f32 v42, v42
    v_rcp_f32 v40, v40
    s_nop 0
    v_pk_mul_f32 v[180:181], v[180:181], v[42:43] op_sel_hi:[1,0]
    v_pk_mul_f32 v[182:183], v[182:183], v[42:43] op_sel_hi:[1,0]
    v_pk_mul_f32 v[184:185], v[184:185], v[42:43] op_sel_hi:[1,0]
    v_pk_mul_f32 v[186:187], v[186:187], v[42:43] op_sel_hi:[1,0]
    v_pk_mul_f32 v[196:197], v[196:197], v[42:43] op_sel_hi:[1,0]
    v_pk_mul_f32 v[198:199], v[198:199], v[42:43] op_sel_hi:[1,0]
    v_pk_mul_f32 v[200:201], v[200:201], v[42:43] op_sel_hi:[1,0]
    v_pk_mul_f32 v[202:203], v[202:203], v[42:43] op_sel_hi:[1,0]
    v_cvt_pk_bf16_f32 v180, v180, v181
    v_cvt_pk_bf16_f32 v181, v182, v183
    v_cvt_pk_bf16_f32 v182, v184, v185
    v_cvt_pk_bf16_f32 v183, v186, v187
    ds_write_b128 v38, v[180:183] offset:0
    v_pk_mul_f32 v[212:213], v[212:213], v[42:43] op_sel_hi:[1,0]
    v_pk_mul_f32 v[214:215], v[214:215], v[42:43] op_sel_hi:[1,0]
    v_pk_mul_f32 v[216:217], v[216:217], v[42:43] op_sel_hi:[1,0]
    v_pk_mul_f32 v[218:219], v[218:219], v[42:43] op_sel_hi:[1,0]
    v_cvt_pk_bf16_f32 v196, v196, v197
    v_cvt_pk_bf16_f32 v197, v198, v199
    v_cvt_pk_bf16_f32 v198, v200, v201
    v_cvt_pk_bf16_f32 v199, v202, v203
    ds_write_b128 v39, v[196:199] offset:0
    v_pk_mul_f32 v[228:229], v[228:229], v[42:43] op_sel_hi:[1,0]
    v_pk_mul_f32 v[230:231], v[230:231], v[42:43] op_sel_hi:[1,0]
    v_pk_mul_f32 v[232:233], v[232:233], v[42:43] op_sel_hi:[1,0]
    v_pk_mul_f32 v[234:235], v[234:235], v[42:43] op_sel_hi:[1,0]
    v_cvt_pk_bf16_f32 v212, v212, v213
    v_cvt_pk_bf16_f32 v213, v214, v215
    v_cvt_pk_bf16_f32 v214, v216, v217
    v_cvt_pk_bf16_f32 v215, v218, v219
    ds_write_b128 v38, v[212:215] offset:8192
    v_pk_mul_f32 v[188:189], v[188:189], v[40:41] op_sel_hi:[1,0]
    v_pk_mul_f32 v[190:191], v[190:191], v[40:41] op_sel_hi:[1,0]
    v_pk_mul_f32 v[192:193], v[192:193], v[40:41] op_sel_hi:[1,0]
    v_pk_mul_f32 v[194:195], v[194:195], v[40:41] op_sel_hi:[1,0]
    v_cvt_pk_bf16_f32 v228, v228, v229
    v_cvt_pk_bf16_f32 v229, v230, v231
    v_cvt_pk_bf16_f32 v230, v232, v233
    v_cvt_pk_bf16_f32 v231, v234, v235
    ds_write_b128 v39, v[228:231] offset:8192
    v_pk_mul_f32 v[204:205], v[204:205], v[40:41] op_sel_hi:[1,0]
    v_pk_mul_f32 v[206:207], v[206:207], v[40:41] op_sel_hi:[1,0]
    v_pk_mul_f32 v[208:209], v[208:209], v[40:41] op_sel_hi:[1,0]
    v_pk_mul_f32 v[210:211], v[210:211], v[40:41] op_sel_hi:[1,0]
    v_cvt_pk_bf16_f32 v188, v188, v189
    v_cvt_pk_bf16_f32 v189, v190, v191
    v_cvt_pk_bf16_f32 v190, v192, v193
    v_cvt_pk_bf16_f32 v191, v194, v195
    ds_write_b128 v38, v[188:191] offset:2048
    v_pk_mul_f32 v[220:221], v[220:221], v[40:41] op_sel_hi:[1,0]
    v_pk_mul_f32 v[222:223], v[222:223], v[40:41] op_sel_hi:[1,0]
    v_pk_mul_f32 v[224:225], v[224:225], v[40:41] op_sel_hi:[1,0]
    v_pk_mul_f32 v[226:227], v[226:227], v[40:41] op_sel_hi:[1,0]
    v_cvt_pk_bf16_f32 v204, v204, v205
    v_cvt_pk_bf16_f32 v205, v206, v207
    v_cvt_pk_bf16_f32 v206, v208, v209
    v_cvt_pk_bf16_f32 v207, v210, v211
    ds_write_b128 v39, v[204:207] offset:2048
    v_pk_mul_f32 v[236:237], v[236:237], v[40:41] op_sel_hi:[1,0]
    v_pk_mul_f32 v[238:239], v[238:239], v[40:41] op_sel_hi:[1,0]
    v_pk_mul_f32 v[240:241], v[240:241], v[40:41] op_sel_hi:[1,0]
    v_pk_mul_f32 v[242:243], v[242:243], v[40:41] op_sel_hi:[1,0]
    v_cvt_pk_bf16_f32 v220, v220, v221
    v_cvt_pk_bf16_f32 v221, v222, v223
    v_cvt_pk_bf16_f32 v222, v224, v225
    v_cvt_pk_bf16_f32 v223, v226, v227
    ds_write_b128 v38, v[220:223] offset:10240
    v_cvt_pk_bf16_f32 v236, v236, v237
    v_cvt_pk_bf16_f32 v237, v238, v239
    v_cvt_pk_bf16_f32 v238, v240, v241
    v_cvt_pk_bf16_f32 v239, v242, v243
    ds_write_b128 v39, v[236:239] offset:10240
    s_cmp_lt_u32 s59, 2
    s_cbranch_scc0 L_feed0
    v_add_u32 v26, s90, v26
    v_add_u32 v27, s90, v27
    v_add_u32 v28, s90, v28
    v_add_u32 v29, s90, v29
    v_add_u32 v30, s90, v30
    v_add_u32 v31, s90, v31
    v_add_u32 v32, s90, v32
    v_add_u32 v33, s90, v33
    v_add_u32 v34, s90, v34
    v_add_u32 v35, s90, v35
    v_add_u32 v1, 0, v0
    v_mul_u32_u24 v6, 2731, v1
    v_lshrrev_b32 v6, 16, v6
    v_mul_u32_u24 v7, 24, v6
    v_sub_u32 v1, v1, v7
    v_and_b32 v7, 6, v6
    v_xor_b32 v1, v1, v7
    v_lshlrev_b32 v1, 4, v1
    v_mul_u32_u24 v6, 1152, v6
    v_add_u32 v1, v1, v6
    v_subrev_u32 v16, 0, v1
    v_add_u32 v1, 64, v0
    v_mul_u32_u24 v6, 2731, v1
    v_lshrrev_b32 v6, 16, v6
    v_mul_u32_u24 v7, 24, v6
    v_sub_u32 v1, v1, v7
    v_and_b32 v7, 6, v6
    v_xor_b32 v1, v1, v7
    v_lshlrev_b32 v1, 4, v1
    v_mul_u32_u24 v6, 1152, v6
    v_add_u32 v1, v1, v6
    v_subrev_u32 v17, 1024, v1
    v_add_u32 v1, 128, v0
    v_mul_u32_u24 v6, 2731, v1
    v_lshrrev_b32 v6, 16, v6
    v_mul_u32_u24 v7, 24, v6
    v_sub_u32 v1, v1, v7
    v_and_b32 v7, 6, v6
    v_xor_b32 v1, v1, v7
    v_lshlrev_b32 v1, 4, v1
    v_mul_u32_u24 v6, 1152, v6
    v_add_u32 v1, v1, v6
    v_subrev_u32 v18, 2048, v1
    v_add_u32 v1, 192, v0
    v_mul_u32_u24 v6, 2731, v1
    v_lshrrev_b32 v6, 16, v6
    v_mul_u32_u24 v7, 24, v6
    v_sub_u32 v1, v1, v7
    v_and_b32 v7, 6, v6
    v_xor_b32 v1, v1, v7
    v_lshlrev_b32 v1, 4, v1
    v_mul_u32_u24 v6, 1152, v6
    v_add_u32 v1, v1, v6
    v_subrev_u32 v19, 3072, v1
    v_add_u32 v1, 256, v0
    v_mul_u32_u24 v6, 2731, v1
    v_lshrrev_b32 v6, 16, v6
    v_mul_u32_u24 v7, 24, v6
    v_sub_u32 v1, v1, v7
    v_and_b32 v7, 6, v6
    v_xor_b32 v1, v1, v7
    v_lshlrev_b32 v1, 4, v1
    v_mul_u32_u24 v6, 1152, v6
    v_add_u32 v1, v1, v6
    v_subrev_u32 v20, 0, v1
    v_add_u32 v1, 320, v0
    v_mul_u32_u24 v6, 2731, v1
    v_lshrrev_b32 v6, 16, v6
    v_mul_u32_u24 v7, 24, v6
    v_sub_u32 v1, v1, v7
    v_and_b32 v7, 6, v6
    v_xor_b32 v1, v1, v7
    v_lshlrev_b32 v1, 4, v1
    v_mul_u32_u24 v6, 1152, v6
    v_add_u32 v1, v1, v6
    v_subrev_u32 v21, 1024, v1
    s_lshl_b32 s46, s5, 9
    s_lshl_b32 s47, s4, 4
    s_add_u32 s46, s46, s47
    s_mul_i32 s42, s46, 1152
    s_and_b32 s43, s7, 3
    s_mul_i32 s52, s4, 6144
    s_cmp_eq_u32 s6, 1
    s_mov_b32 s60, 98304
    s_mov_b32 s61, 65536
    s_cselect_b32 s62, 0, 32768
    s_cselect_b32 s63, 32768, 0
    s_mov_b32 s41, 5
    s_mov_b32 s91, 0
    s_waitcnt lgkmcnt(0)
    s_branch L_stage
L_feed0:
    s_mov_b32 s72, 2808293713
    s_mov_b32 s73, 11
    s_setprio 1
    s_mov_b32 s44, 0
    s_add_u32 s46, s41, s43
    s_and_b32 s46, s46, 3
    s_lshr_b32 s47, s41, 2
    s_lshl_b32 s47, s47, 2
    s_add_u32 s46, s46, s47
    s_mul_i32 s46, s46, 73728
    s_add_u32 s46, s46, s91
    s_add_u32 s47, s63, s52
    s_mov_b32 m0, s47
    s_add_u32 s46, s46, s42
    s_waitcnt lgkmcnt(0)
L_feed:
    s_barrier
    buffer_load_dwordx4 v16, s[24:27], s46 offen offset:0 lds
    s_lshr_b64 s[72:73], s[72:73], 4
    s_and_b32 s41, s72, 3
    s_or_b32 s41, s41, 4
    s_bfe_u32 s91, s72, 0x20002
    s_mul_i32 s91, s91, 384
    buffer_load_dwordx4 v17, s[24:27], s46 offen offset:1024 lds
    s_mov_b32 s48, s63
    s_mov_b32 s63, s60
    s_mov_b32 s60, s61
    s_mov_b32 s61, s62
    s_mov_b32 s62, s48
    buffer_load_dwordx4 v18, s[24:27], s46 offen offset:2048 lds
    s_add_u32 s48, s41, s43
    s_and_b32 s48, s48, 3
    s_lshr_b32 s45, s41, 2
    s_lshl_b32 s45, s45, 2
    s_add_u32 s48, s48, s45
    buffer_load_dwordx4 v19, s[24:27], s46 offen offset:3072 lds
    s_add_u32 m0, s47, 4096
    s_mul_i32 s48, s48, 73728
    s_add_u32 s48, s48, s91
    s_add_u32 s45, s63, s52
    s_add_u32 s48, s48, s42
    buffer_load_dwordx4 v20, s[24:27], s46 offen offset:0 lds
    s_add_u32 s44, s44, 1
    s_mov_b32 s47, s45
    s_cmp_lt_u32 s44, 9
    buffer_load_dwordx4 v21, s[24:27], s46 offen offset:1024 lds
    s_mov_b32 m0, s45
    s_mov_b32 s46, s48
    s_waitcnt vmcnt(12)
    s_cbranch_scc1 L_feed
    s_barrier
    s_waitcnt vmcnt(6)
    s_barrier
    s_waitcnt vmcnt(0)
    s_barrier
L_reduce:
    s_setprio 0
    s_lshr_b32 s59, s3, 2
    s_lshl_b32 s47, s59, 2
    s_add_u32 s47, s47, 122888
    v_mov_b32 v9, s47
    s_mov_b32 s89, 65536
    s_cmp_lg_u32 s4, 0
    s_cbranch_scc1 L_red_work
    s_lshl_b32 s46, s59, 14
    s_add_u32 s88, s88, s46
    v_mov_b32 v4, 0
    v_and_b32 v8, 7, v0
    v_lshlrev_b32 v8, 7, v8
    s_cmp_eq_u32 s59, 1
    s_cbranch_scc1 L_red_poll
    s_mov_b32 s76, s82
    s_and_b32 s77, s83, 0xffff
    s_mov_b32 s78, 256
    s_mov_b32 s79, 0x20000
    s_lshl_b32 s48, s7, 2
    s_mov_b32 s89, 65536
L_sp1:
    buffer_load_dword v5, v4, s[76:79], s48 offen offset:0 sc1
    s_waitcnt vmcnt(0) lgkmcnt(0)
    v_readfirstlane_b32 s47, v5
    s_cmp_ge_u32 s47, 16
    s_cbranch_scc1 L_se2
    s_sleep 1
    s_sub_u32 s89, s89, 1
    s_cmp_lg_u32 s89, 0
    s_cbranch_scc1 L_sp1
L_se2:
    s_mov_b32 s89, 65536
L_red_poll:
L_red_again:
    buffer_load_dword v16, v8, s[28:31], s88 offen sc1
    s_waitcnt vmcnt(0)
    v_cmp_eq_u32 vcc, 1, v16
    s_and_b32 s48, vcc_lo, 0xff
    s_sub_u32 s89, s89, 1
    s_cselect_b32 s48, 0xff, s48
    v_mov_b32 v10, s48
    ds_write_b32 v9, v10
    s_cmp_eq_u32 s48, 0xff
    s_cbranch_scc1 L_red_end
    s_sleep 2
    s_branch L_red_again
L_red_work:
    s_mov_b32 s16, s80
    s_and_b32 s17, s81, 0xffff
    s_mov_b32 s18, 2359296
    s_mov_b32 s19, 0x20000
    s_lshl_b32 s44, s6, 3
    s_add_u32 s44, s44, s5
    s_sub_u32 s46, s4, 1
    s_lshl_b32 s46, s46, 4
    s_add_u32 s44, s44, s46
    s_mul_i32 s44, s44, 3
    s_lshl_b32 s46, s59, 4
    s_add_u32 s46, s46, s7
    s_mul_i32 s45, s46, 589824
    s_mul_i32 s42, s7, 147456
    s_mul_i32 s46, s59, 1152
    s_add_u32 s42, s42, s46
    v_bfe_u32 v10, v0, 2, 2
    v_and_b32 v11, 3, v0
    v_bfe_u32 v12, v0, 4, 1
    v_lshrrev_b32 v1, 5, v0
    v_add_u32 v1, s44, v1
    v_lshrrev_b32 v13, 4, v1
    v_bfe_u32 v16, v1, 3, 1
    v_and_b32 v1, 7, v1
    v_lshl_add_u32 v1, v1, 1, v12
    v_lshl_add_u32 v17, v13, 2, v10
    v_lshl_add_u32 v17, v17, 1, v16
    v_lshl_add_u32 v18, v1, 2, v11
    v_lshlrev_b32 v18, 4, v18
    v_lshl_add_u32 v6, v17, 10, v18
    v_lshl_add_u32 v1, v16, 5, v1
    v_mul_u32_u24 v1, 2304, v1
    v_lshl_add_u32 v1, v13, 7, v1
    v_lshl_add_u32 v1, v10, 5, v1
    v_lshl_add_u32 v14, v11, 3, v1
    v_and_b32 v1, 1, v0
    v_mul_u32_u24 v1, 36856, v1
    v_add_u32 v14, v14, v1
    s_add_u32 s44, s44, 2
    v_mov_b32 v1, s44
    v_lshrrev_b32 v13, 4, v1
    v_bfe_u32 v16, v1, 3, 1
    v_and_b32 v1, 7, v1
    v_lshl_add_u32 v1, v1, 1, v12
    v_lshl_add_u32 v17, v13, 2, v10
    v_lshl_add_u32 v17, v17, 1, v16
    v_lshl_add_u32 v18, v1, 2, v11
    v_lshlrev_b32 v18, 4, v18
    v_lshl_add_u32 v7, v17, 10, v18
    v_lshl_add_u32 v1, v16, 5, v1
    v_mul_u32_u24 v1, 2304, v1
    v_lshl_add_u32 v1, v13, 7, v1
    v_lshl_add_u32 v1, v10, 5, v1
    v_lshl_add_u32 v15, v11, 3, v1
    v_and_b32 v1, 1, v0
    v_mul_u32_u24 v1, 36856, v1
    v_add_u32 v15, v15, v1
    v_and_b32 v1, 1, v0
    v_cmp_eq_u32 vcc, 1, v1
    v_mov_b32 v104, 0
    v_mov_b32 v105, 0
    v_mov_b32 v106, 0
    v_mov_b32 v107, 0
    v_mov_b32 v108, 0
    v_mov_b32 v109, 0
    v_mov_b32 v110, 0
    v_mov_b32 v111, 0
    v_mov_b32 v112, 0
    v_mov_b32 v113, 0
    v_mov_b32 v114, 0
    v_mov_b32 v115, 0
    v_mov_b32 v116, 0
    v_mov_b32 v117, 0
    v_mov_b32 v118, 0
    v_mov_b32 v119, 0
    s_mov_b32 s44, 0
    s_mov_b32 s91, 0
L_red_look:
    ds_read_b32 v5, v9
    s_waitcnt lgkmcnt(0)
    v_readfirstlane_b32 s48, v5
    s_sub_u32 s89, s89, 1
    s_cselect_b32 s48, 0xff, s48
    s_andn2_b32 s48, s48, s44
    s_cbranch_scc1 L_red_new
    s_getreg_b32 s46, hwreg(HW_REG_IB_STS)
    s_and_b32 s46, s46, 0xc000000f
    s_cselect_b32 s46, 0, s91
    s_cmp_lg_u32 s46, 0
    s_cbranch_scc1 L_red_add
    s_sleep 1
    s_branch L_red_look
L_red_new:
    s_or_b32 s44, s44, s48
    s_or_b32 s91, s91, s48
    s_bitcmp1_b32 s48, 0
    s_cbranch_scc0 L_red_h0
    s_add_u32 s46, s45, 0
    buffer_load_dwordx4 v[40:43], v6, s[28:31], s46 offen sc1
    s_mov_b32 exec_hi, 0
    buffer_load_dwordx4 v[72:75], v7, s[28:31], s46 offen sc1
    s_mov_b32 exec_hi, -1
L_red_h0:
    s_bitcmp1_b32 s48, 1
    s_cbranch_scc0 L_red_h1
    s_add_u32 s46, s45, 73728
    buffer_load_dwordx4 v[44:47], v6, s[28:31], s46 offen sc1
    s_mov_b32 exec_hi, 0
    buffer_load_dwordx4 v[76:79], v7, s[28:31], s46 offen sc1
    s_mov_b32 exec_hi, -1
L_red_h1:
    s_bitcmp1_b32 s48, 2
    s_cbranch_scc0 L_red_h2
    s_add_u32 s46, s45, 147456
    buffer_load_dwordx4 v[48:51], v6, s[28:31], s46 offen sc1
    s_mov_b32 exec_hi, 0
    buffer_load_dwordx4 v[80:83], v7, s[28:31], s46 offen sc1
    s_mov_b32 exec_hi, -1
L_red_h2:
    s_bitcmp1_b32 s48, 3
    s_cbranch_scc0 L_red_h3
    s_add_u32 s46, s45, 221184
    buffer_load_dwordx4 v[52:55], v6, s[28:31], s46 offen sc1
    s_mov_b32 exec_hi, 0
    buffer_load_dwordx4 v[84:87], v7, s[28:31], s46 offen sc1
    s_mov_b32 exec_hi, -1
L_red_h3:
    s_bitcmp1_b32 s48, 4
    s_cbranch_scc0 L_red_h4
    s_add_u32 s46, s45, 294912
    buffer_load_dwordx4 v[56:59], v6, s[28:31], s46 offen sc1
    s_mov_b32 exec_hi, 0
    buffer_load_dwordx4 v[88:91], v7, s[28:31], s46 offen sc1
    s_mov_b32 exec_hi, -1
L_red_h4:
    s_bitcmp1_b32 s48, 5
    s_cbranch_scc0 L_red_h5
    s_add_u32 s46, s45, 368640
    buffer_load_dwordx4 v[60:63], v6, s[28:31], s46 offen sc1
    s_mov_b32 exec_hi, 0
    buffer_load_dwordx4 v[92:95], v7, s[28:31], s46 offen sc1
    s_mov_b32 exec_hi, -1
L_red_h5:
    s_bitcmp1_b32 s48, 6
    s_cbranch_scc0 L_red_h6
    s_add_u32 s46, s45, 442368
    buffer_load_dwordx4 v[64:67], v6, s[28:31], s46 offen sc1
    s_mov_b32 exec_hi, 0
    buffer_load_dwordx4 v[96:99], v7, s[28:31], s46 offen sc1
    s_mov_b32 exec_hi, -1
L_red_h6:
    s_bitcmp1_b32 s48, 7
    s_cbranch_scc0 L_red_h7
    s_add_u32 s46, s45, 516096
    buffer_load_dwordx4 v[68:71], v6, s[28:31], s46 offen sc1
    s_mov_b32 exec_hi, 0
    buffer_load_dwordx4 v[100:103], v7, s[28:31], s46 offen sc1
    s_mov_b32 exec_hi, -1
L_red_h7:
    s_cmp_lg_u32 s44, 0xff
    s_cbranch_scc1 L_red_look
L_red_add:
    s_waitcnt vmcnt(0)
    s_bitcmp1_b32 s91, 0
    s_cbranch_scc0 L_red_a0
    v_lshlrev_b32 v10, 16, v40
    v_and_b32 v11, 0xffff0000, v40
    v_pk_add_f32 v[104:105], v[104:105], v[10:11]
    v_lshlrev_b32 v12, 16, v41
    v_and_b32 v13, 0xffff0000, v41
    v_pk_add_f32 v[106:107], v[106:107], v[12:13]
    v_lshlrev_b32 v10, 16, v42
    v_and_b32 v11, 0xffff0000, v42
    v_pk_add_f32 v[108:109], v[108:109], v[10:11]
    v_lshlrev_b32 v12, 16, v43
    v_and_b32 v13, 0xffff0000, v43
    v_pk_add_f32 v[110:111], v[110:111], v[12:13]
    v_lshlrev_b32 v10, 16, v72
    v_and_b32 v11, 0xffff0000, v72
    v_pk_add_f32 v[112:113], v[112:113], v[10:11]
    v_lshlrev_b32 v12, 16, v73
    v_and_b32 v13, 0xffff0000, v73
    v_pk_add_f32 v[114:115], v[114:115], v[12:13]
    v_lshlrev_b32 v10, 16, v74
    v_and_b32 v11, 0xffff0000, v74
    v_pk_add_f32 v[116:117], v[116:117], v[10:11]
    v_lshlrev_b32 v12, 16, v75
    v_and_b32 v13, 0xffff0000, v75
    v_pk_add_f32 v[118:119], v[118:119], v[12:13]
L_red_a0:
    s_bitcmp1_b32 s91, 1
    s_cbranch_scc0 L_red_a1
    v_lshlrev_b32 v10, 16, v44
    v_and_b32 v11, 0xffff0000, v44
    v_pk_add_f32 v[104:105], v[104:105], v[10:11]
    v_lshlrev_b32 v12, 16, v45
    v_and_b32 v13, 0xffff0000, v45
    v_pk_add_f32 v[106:107], v[106:107], v[12:13]
    v_lshlrev_b32 v10, 16, v46
    v_and_b32 v11, 0xffff0000, v46
    v_pk_add_f32 v[108:109], v[108:109], v[10:11]
    v_lshlrev_b32 v12, 16, v47
    v_and_b32 v13, 0xffff0000, v47
    v_pk_add_f32 v[110:111], v[110:111], v[12:13]
    v_lshlrev_b32 v10, 16, v76
    v_and_b32 v11, 0xffff0000, v76
    v_pk_add_f32 v[112:113], v[112:113], v[10:11]
    v_lshlrev_b32 v12, 16, v77
    v_and_b32 v13, 0xffff0000, v77
    v_pk_add_f32 v[114:115], v[114:115], v[12:13]
    v_lshlrev_b32 v10, 16, v78
    v_and_b32 v11, 0xffff0000, v78
    v_pk_add_f32 v[116:117], v[116:117], v[10:11]
    v_lshlrev_b32 v12, 16, v79
    v_and_b32 v13, 0xffff0000, v79
    v_pk_add_f32 v[118:119], v[118:119], v[12:13]
L_red_a1:
    s_bitcmp1_b32 s91, 2
    s_cbranch_scc0 L_red_a2
    v_lshlrev_b32 v10, 16, v48
    v_and_b32 v11, 0xffff0000, v48
    v_pk_add_f32 v[104:105], v[104:105], v[10:11]
    v_lshlrev_b32 v12, 16, v49
    v_and_b32 v13, 0xffff0000, v49
    v_pk_add_f32 v[106:107], v[106:107], v[12:13]
    v_lshlrev_b32 v10, 16, v50
    v_and_b32 v11, 0xffff0000, v50
    v_pk_add_f32 v[108:109], v[108:109], v[10:11]
    v_lshlrev_b32 v12, 16, v51
    v_and_b32 v13, 0xffff0000, v51
    v_pk_add_f32 v[110:111], v[110:111], v[12:13]
    v_lshlrev_b32 v10, 16, v80
    v_and_b32 v11, 0xffff0000, v80
    v_pk_add_f32 v[112:113], v[112:113], v[10:11]
    v_lshlrev_b32 v12, 16, v81
    v_and_b32 v13, 0xffff0000, v81
    v_pk_add_f32 v[114:115], v[114:115], v[12:13]
    v_lshlrev_b32 v10, 16, v82
    v_and_b32 v11, 0xffff0000, v82
    v_pk_add_f32 v[116:117], v[116:117], v[10:11]
    v_lshlrev_b32 v12, 16, v83
    v_and_b32 v13, 0xffff0000, v83
    v_pk_add_f32 v[118:119], v[118:119], v[12:13]
L_red_a2:
    s_bitcmp1_b32 s91, 3
    s_cbranch_scc0 L_red_a3
    v_lshlrev_b32 v10, 16, v52
    v_and_b32 v11, 0xffff0000, v52
    v_pk_add_f32 v[104:105], v[104:105], v[10:11]
    v_lshlrev_b32 v12, 16, v53
    v_and_b32 v13, 0xffff0000, v53
    v_pk_add_f32 v[106:107], v[106:107], v[12:13]
    v_lshlrev_b32 v10, 16, v54
    v_and_b32 v11, 0xffff0000, v54
    v_pk_add_f32 v[108:109], v[108:109], v[10:11]
    v_lshlrev_b32 v12, 16, v55
    v_and_b32 v13, 0xffff0000, v55
    v_pk_add_f32 v[110:111], v[110:111], v[12:13]
    v_lshlrev_b32 v10, 16, v84
    v_and_b32 v11, 0xffff0000, v84
    v_pk_add_f32 v[112:113], v[112:113], v[10:11]
    v_lshlrev_b32 v12, 16, v85
    v_and_b32 v13, 0xffff0000, v85
    v_pk_add_f32 v[114:115], v[114:115], v[12:13]
    v_lshlrev_b32 v10, 16, v86
    v_and_b32 v11, 0xffff0000, v86
    v_pk_add_f32 v[116:117], v[116:117], v[10:11]
    v_lshlrev_b32 v12, 16, v87
    v_and_b32 v13, 0xffff0000, v87
    v_pk_add_f32 v[118:119], v[118:119], v[12:13]
L_red_a3:
    s_bitcmp1_b32 s91, 4
    s_cbranch_scc0 L_red_a4
    v_lshlrev_b32 v10, 16, v56
    v_and_b32 v11, 0xffff0000, v56
    v_pk_add_f32 v[104:105], v[104:105], v[10:11]
    v_lshlrev_b32 v12, 16, v57
    v_and_b32 v13, 0xffff0000, v57
    v_pk_add_f32 v[106:107], v[106:107], v[12:13]
    v_lshlrev_b32 v10, 16, v58
    v_and_b32 v11, 0xffff0000, v58
    v_pk_add_f32 v[108:109], v[108:109], v[10:11]
    v_lshlrev_b32 v12, 16, v59
    v_and_b32 v13, 0xffff0000, v59
    v_pk_add_f32 v[110:111], v[110:111], v[12:13]
    v_lshlrev_b32 v10, 16, v88
    v_and_b32 v11, 0xffff0000, v88
    v_pk_add_f32 v[112:113], v[112:113], v[10:11]
    v_lshlrev_b32 v12, 16, v89
    v_and_b32 v13, 0xffff0000, v89
    v_pk_add_f32 v[114:115], v[114:115], v[12:13]
    v_lshlrev_b32 v10, 16, v90
    v_and_b32 v11, 0xffff0000, v90
    v_pk_add_f32 v[116:117], v[116:117], v[10:11]
    v_lshlrev_b32 v12, 16, v91
    v_and_b32 v13, 0xffff0000, v91
    v_pk_add_f32 v[118:119], v[118:119], v[12:13]
L_red_a4:
    s_bitcmp1_b32 s91, 5
    s_cbranch_scc0 L_red_a5
    v_lshlrev_b32 v10, 16, v60
    v_and_b32 v11, 0xffff0000, v60
    v_pk_add_f32 v[104:105], v[104:105], v[10:11]
    v_lshlrev_b32 v12, 16, v61
    v_and_b32 v13, 0xffff0000, v61
    v_pk_add_f32 v[106:107], v[106:107], v[12:13]
    v_lshlrev_b32 v10, 16, v62
    v_and_b32 v11, 0xffff0000, v62
    v_pk_add_f32 v[108:109], v[108:109], v[10:11]
    v_lshlrev_b32 v12, 16, v63
    v_and_b32 v13, 0xffff0000, v63
    v_pk_add_f32 v[110:111], v[110:111], v[12:13]
    v_lshlrev_b32 v10, 16, v92
    v_and_b32 v11, 0xffff0000, v92
    v_pk_add_f32 v[112:113], v[112:113], v[10:11]
    v_lshlrev_b32 v12, 16, v93
    v_and_b32 v13, 0xffff0000, v93
    v_pk_add_f32 v[114:115], v[114:115], v[12:13]
    v_lshlrev_b32 v10, 16, v94
    v_and_b32 v11, 0xffff0000, v94
    v_pk_add_f32 v[116:117], v[116:117], v[10:11]
    v_lshlrev_b32 v12, 16, v95
    v_and_b32 v13, 0xffff0000, v95
    v_pk_add_f32 v[118:119], v[118:119], v[12:13]
L_red_a5:
    s_bitcmp1_b32 s91, 6
    s_cbranch_scc0 L_red_a6
    v_lshlrev_b32 v10, 16, v64
    v_and_b32 v11, 0xffff0000, v64
    v_pk_add_f32 v[104:105], v[104:105], v[10:11]
    v_lshlrev_b32 v12, 16, v65
    v_and_b32 v13, 0xffff0000, v65
    v_pk_add_f32 v[106:107], v[106:107], v[12:13]
    v_lshlrev_b32 v10, 16, v66
    v_and_b32 v11, 0xffff0000, v66
    v_pk_add_f32 v[108:109], v[108:109], v[10:11]
    v_lshlrev_b32 v12, 16, v67
    v_and_b32 v13, 0xffff0000, v67
    v_pk_add_f32 v[110:111], v[110:111], v[12:13]
    v_lshlrev_b32 v10, 16, v96
    v_and_b32 v11, 0xffff0000, v96
    v_pk_add_f32 v[112:113], v[112:113], v[10:11]
    v_lshlrev_b32 v12, 16, v97
    v_and_b32 v13, 0xffff0000, v97
    v_pk_add_f32 v[114:115], v[114:115], v[12:13]
    v_lshlrev_b32 v10, 16, v98
    v_and_b32 v11, 0xffff0000, v98
    v_pk_add_f32 v[116:117], v[116:117], v[10:11]
    v_lshlrev_b32 v12, 16, v99
    v_and_b32 v13, 0xffff0000, v99
    v_pk_add_f32 v[118:119], v[118:119], v[12:13]
L_red_a6:
    s_bitcmp1_b32 s91, 7
    s_cbranch_scc0 L_red_a7
    v_lshlrev_b32 v10, 16, v68
    v_and_b32 v11, 0xffff0000, v68
    v_pk_add_f32 v[104:105], v[104:105], v[10:11]
    v_lshlrev_b32 v12, 16, v69
    v_and_b32 v13, 0xffff0000, v69
    v_pk_add_f32 v[106:107], v[106:107], v[12:13]
    v_lshlrev_b32 v10, 16, v70
    v_and_b32 v11, 0xffff0000, v70
    v_pk_add_f32 v[108:109], v[108:109], v[10:11]
    v_lshlrev_b32 v12, 16, v71
    v_and_b32 v13, 0xffff0000, v71
    v_pk_add_f32 v[110:111], v[110:111], v[12:13]
    v_lshlrev_b32 v10, 16, v100
    v_and_b32 v11, 0xffff0000, v100
    v_pk_add_f32 v[112:113], v[112:113], v[10:11]
    v_lshlrev_b32 v12, 16, v101
    v_and_b32 v13, 0xffff0000, v101
    v_pk_add_f32 v[114:115], v[114:115], v[12:13]
    v_lshlrev_b32 v10, 16, v102
    v_and_b32 v11, 0xffff0000, v102
    v_pk_add_f32 v[116:117], v[116:117], v[10:11]
    v_lshlrev_b32 v12, 16, v103
    v_and_b32 v13, 0xffff0000, v103
    v_pk_add_f32 v[118:119], v[118:119], v[12:13]
L_red_a7:
    s_mov_b32 s91, 0
    s_cmp_lg_u32 s44, 0xff
    s_cbranch_scc1 L_red_look
    s_add_u32 s46, s42, 36864
    v_cvt_pk_bf16_f32 v120, v104, v105
    v_cvt_pk_bf16_f32 v121, v106, v107
    v_cvt_pk_bf16_f32 v122, v108, v109
    v_cvt_pk_bf16_f32 v123, v110, v111
    v_cndmask_b32 v10, v122, v120, vcc
    v_cndmask_b32 v11, v123, v121, vcc
    s_nop 1
    v_mov_b32_dpp v12, v10 quad_perm:[1,0,3,2] row_mask:0xf bank_mask:0xf
    v_mov_b32_dpp v13, v11 quad_perm:[1,0,3,2] row_mask:0xf bank_mask:0xf
    v_cndmask_b32 v120, v120, v12, vcc
    v_cndmask_b32 v121, v121, v13, vcc
    v_cndmask_b32 v122, v12, v122, vcc
    v_cndmask_b32 v123, v13, v123, vcc
    buffer_store_dwordx4 v[120:123], v14, s[16:19], s42 offen sc1
    s_mov_b32 exec_hi, 0
    v_cvt_pk_bf16_f32 v124, v112, v113
    v_cvt_pk_bf16_f32 v125, v114, v115
    v_cvt_pk_bf16_f32 v126, v116, v117
    v_cvt_pk_bf16_f32 v127, v118, v119
    v_cndmask_b32 v10, v126, v124, vcc
    v_cndmask_b32 v11, v127, v125, vcc
    s_nop 1
    v_mov_b32_dpp v12, v10 quad_perm:[1,0,3,2] row_mask:0xf bank_mask:0xf
    v_mov_b32_dpp v13, v11 quad_perm:[1,0,3,2] row_mask:0xf bank_mask:0xf
    v_cndmask_b32 v124, v124, v12, vcc
    v_cndmask_b32 v125, v125, v13, vcc
    v_cndmask_b32 v126, v12, v126, vcc
    v_cndmask_b32 v127, v13, v127, vcc
    buffer_store_dwordx4 v[124:127], v15, s[16:19], s42 offen sc1
L_red_end:
    s_endpgm
L_rescale:
    v_mov_b32 v44, v40
    v_mov_b32 v45, v41
    s_nop 1
    v_permlane32_swap_b32 v40, v44
    v_permlane32_swap_b32 v41, v45
    v_max_f32 v40, v40, v44
    v_max_f32 v41, v41, v45
    v_mov_b32 v44, v40
    v_mov_b32 v45, v41
    s_nop 1
    v_permlane16_swap_b32 v40, v44
    v_permlane16_swap_b32 v41, v45
    v_max3_f32 v40, v40, v44, s57
    v_max3_f32 v41, v41, v45, s57
    v_max_f32 v46, 0, v40
    v_max_f32 v48, 0, v41
    v_exp_f32 v46, -v46
    v_exp_f32 v48, -v48
    s_mov_b32 s56, 0x41000000
    s_mov_b32 s57, 0
    v_mul_f32 v46, s66, v46
    v_mul_f32 v48, s66, v48
    s_mov_b32 s66, 1.0
    v_sub_f32 v52, v52, v40
    v_sub_f32 v53, v53, v40
    v_sub_f32 v54, v54, v40
    v_sub_f32 v55, v55, v40
    v_sub_f32 v56, v56, v40
    v_sub_f32 v57, v57, v40
    v_sub_f32 v58, v58, v40
    v_sub_f32 v59, v59, v40
    v_sub_f32 v68, v68, v40
    v_sub_f32 v69, v69, v40
    v_sub_f32 v70, v70, v40
    v_sub_f32 v71, v71, v40
    v_pk_mul_f32 v[76:77], v[76:77], v[46:47] op_sel_hi:[1,0]
    v_pk_mul_f32 v[180:181], v[180:181], v[46:47] op_sel_hi:[1,0]
    v_pk_mul_f32 v[182:183], v[182:183], v[46:47] op_sel_hi:[1,0]
    v_pk_mul_f32 v[184:185], v[184:185], v[46:47] op_sel_hi:[1,0]
    v_pk_mul_f32 v[186:187], v[186:187], v[46:47] op_sel_hi:[1,0]
    v_pk_mul_f32 v[196:197], v[196:197], v[46:47] op_sel_hi:[1,0]
    v_pk_mul_f32 v[198:199], v[198:199], v[46:47] op_sel_hi:[1,0]
    v_pk_mul_f32 v[200:201], v[200:201], v[46:47] op_sel_hi:[1,0]
    v_pk_mul_f32 v[202:203], v[202:203], v[46:47] op_sel_hi:[1,0]
    v_pk_mul_f32 v[212:213], v[212:213], v[46:47] op_sel_hi:[1,0]
    v_pk_mul_f32 v[214:215], v[214:215], v[46:47] op_sel_hi:[1,0]
    v_pk_mul_f32 v[216:217], v[216:217], v[46:47] op_sel_hi:[1,0]
    v_pk_mul_f32 v[218:219], v[218:219], v[46:47] op_sel_hi:[1,0]
    v_pk_mul_f32 v[228:229], v[228:229], v[46:47] op_sel_hi:[1,0]
    v_pk_mul_f32 v[230:231], v[230:231], v[46:47] op_sel_hi:[1,0]
    v_pk_mul_f32 v[232:233], v[232:233], v[46:47] op_sel_hi:[1,0]
    v_pk_mul_f32 v[234:235], v[234:235], v[46:47] op_sel_hi:[1,0]
    v_sub_f32 v60, v60, v41
    v_sub_f32 v61, v61, v41
    v_sub_f32 v62, v62, v41
    v_sub_f32 v63, v63, v41
    v_sub_f32 v64, v64, v41
    v_sub_f32 v65, v65, v41
    v_sub_f32 v66, v66, v41
    v_sub_f32 v67, v67, v41
    v_sub_f32 v72, v72, v41
    v_sub_f32 v73, v73, v41
    v_sub_f32 v74, v74, v41
    v_sub_f32 v75, v75, v41
    v_pk_mul_f32 v[78:79], v[78:79], v[48:49] op_sel_hi:[1,0]
    v_pk_mul_f32 v[188:189], v[188:189], v[48:49] op_sel_hi:[1,0]
    v_pk_mul_f32 v[190:191], v[190:191], v[48:49] op_sel_hi:[1,0]
    v_pk_mul_f32 v[192:193], v[192:193], v[48:49] op_sel_hi:[1,0]
    v_pk_mul_f32 v[194:195], v[194:195], v[48:49] op_sel_hi:[1,0]
    v_pk_mul_f32 v[204:205], v[204:205], v[48:49] op_sel_hi:[1,0]
    v_pk_mul_f32 v[206:207], v[206:207], v[48:49] op_sel_hi:[1,0]
    v_pk_mul_f32 v[208:209], v[208:209], v[48:49] op_sel_hi:[1,0]
    v_pk_mul_f32 v[210:211], v[210:211], v[48:49] op_sel_hi:[1,0]
    v_pk_mul_f32 v[220:221], v[220:221], v[48:49] op_sel_hi:[1,0]
    v_pk_mul_f32 v[222:223], v[222:223], v[48:49] op_sel_hi:[1,0]
    v_pk_mul_f32 v[224:225], v[224:225], v[48:49] op_sel_hi:[1,0]
    v_pk_mul_f32 v[226:227], v[226:227], v[48:49] op_sel_hi:[1,0]
    v_pk_mul_f32 v[236:237], v[236:237], v[48:49] op_sel_hi:[1,0]
    v_pk_mul_f32 v[238:239], v[238:239], v[48:49] op_sel_hi:[1,0]
    v_pk_mul_f32 v[240:241], v[240:241], v[48:49] op_sel_hi:[1,0]
    v_pk_mul_f32 v[242:243], v[242:243], v[48:49] op_sel_hi:[1,0]
    s_branch L_tile_exp
L_pj_rest:
    v_lshlrev_b32 v7, 7, v0
    v_mov_b32 v33, v31
    v_mov_b32 v34, v32
    s_setprio 1
    s_cmp_eq_u32 s6, 1
    s_cbranch_scc1 L_q1_1
    s_load_dwordx2 s[72:73], s[0:1], 56
    s_waitcnt lgkmcnt(0)
    s_and_b32 s73, s73, 0xffff
    s_mov_b32 s74, 67108864
    s_mov_b32 s75, 0x20000
L_q1_0:
    s_barrier
    ds_read_b64_tr_b16 v[36:37], v24 offset:0
    ds_read_b64_tr_b16 v[38:39], v24 offset:512
    ds_read_b64_tr_b16 v[40:41], v25 offset:0
    ds_read_b64_tr_b16 v[42:43], v25 offset:512
    ds_read_b64_tr_b16 v[44:45], v26 offset:0
    ds_read_b64_tr_b16 v[46:47], v26 offset:512
    ds_read_b64_tr_b16 v[48:49], v27 offset:0
    ds_read_b64_tr_b16 v[50:51], v27 offset:512
    ds_read_b64_tr_b16 v[52:53], v24 offset:4096
    ds_read_b64_tr_b16 v[54:55], v24 offset:4608
    ds_read_b64_tr_b16 v[56:57], v25 offset:4096
    ds_read_b64_tr_b16 v[58:59], v25 offset:4608
    ds_read_b64_tr_b16 v[60:61], v26 offset:4096
    ds_read_b64_tr_b16 v[62:63], v26 offset:4608
    ds_read_b64_tr_b16 v[64:65], v27 offset:4096
    s_waitcnt lgkmcnt(14)
    ds_read_b64_tr_b16 v[66:67], v27 offset:4608
    s_waitcnt lgkmcnt(0)
    s_barrier
    ds_read_b128 v[72:75], v33 offset:0
    ds_read_b128 v[76:79], v33 offset:2048
    ds_read_b128 v[80:83], v33 offset:4096
    ds_read_b128 v[84:87], v33 offset:6144
    ds_read_b128 v[88:91], v34 offset:0
    ds_read_b128 v[92:95], v34 offset:2048
    ds_read_b128 v[96:99], v34 offset:4096
    ds_read_b128 v[100:103], v34 offset:6144
    s_lshl_b32 s46, s36, 19
    s_add_u32 s46, s46, s35
    s_mov_b32 m0, s51
    s_sub_u32 s36, s36, 1
    s_cselect_b32 s36, 8, s36
    buffer_load_dwordx4 v22, s[20:23], s46 offen offset:0 lds
    s_waitcnt lgkmcnt(7)
    v_mfma_f32_16x16x32_bf16 v[168:171], v[36:39], v[72:75], v[168:171]
    s_waitcnt lgkmcnt(6)
    v_mfma_f32_16x16x32_bf16 v[172:175], v[36:39], v[76:79], v[172:175]
    s_waitcnt lgkmcnt(5)
    v_mfma_f32_16x16x32_bf16 v[176:179], v[36:39], v[80:83], v[176:179]
    s_add_u32 s46, s46, 64512
    buffer_load_dwordx4 v23, s[20:23], s46 offen offset:1024 lds
    s_waitcnt lgkmcnt(4)
    v_mfma_f32_16x16x32_bf16 v[180:183], v[36:39], v[84:87], v[180:183]
    v_mfma_f32_16x16x32_bf16 v[184:187], v[40:43], v[72:75], v[184:187]
    s_add_u32 s46, s46, 64512
    buffer_load_dwordx4 v22, s[20:23], s46 offen offset:2048 lds
    v_mfma_f32_16x16x32_bf16 v[188:191], v[40:43], v[76:79], v[188:191]
    v_mfma_f32_16x16x32_bf16 v[192:195], v[40:43], v[80:83], v[192:195]
    v_mfma_f32_16x16x32_bf16 v[196:199], v[40:43], v[84:87], v[196:199]
    s_add_u32 s46, s46, 64512
    buffer_load_dwordx4 v23, s[20:23], s46 offen offset:3072 lds
    v_mfma_f32_16x16x32_bf16 v[200:203], v[44:47], v[72:75], v[200:203]
    v_mfma_f32_16x16x32_bf16 v[204:207], v[44:47], v[76:79], v[204:207]
    s_add_u32 m0, s51, 4096
    s_add_u32 s46, s46, 68608
    buffer_load_dwordx4 v22, s[20:23], s46 offen offset:0 lds
    v_mfma_f32_16x16x32_bf16 v[208:211], v[44:47], v[80:83], v[208:211]
    v_mfma_f32_16x16x32_bf16 v[212:215], v[44:47], v[84:87], v[212:215]
    v_mfma_f32_16x16x32_bf16 v[216:219], v[48:51], v[72:75], v[216:219]
    s_add_u32 s46, s46, 64512
    buffer_load_dwordx4 v23, s[20:23], s46 offen offset:1024 lds
    v_mfma_f32_16x16x32_bf16 v[220:223], v[48:51], v[76:79], v[220:223]
    v_mfma_f32_16x16x32_bf16 v[224:227], v[48:51], v[80:83], v[224:227]
    s_add_u32 s46, s46, 64512
    buffer_load_dwordx4 v22, s[20:23], s46 offen offset:2048 lds
    v_mfma_f32_16x16x32_bf16 v[228:231], v[48:51], v[84:87], v[228:231]
    s_waitcnt lgkmcnt(3)
    v_mfma_f32_16x16x32_bf16 v[168:171], v[52:55], v[88:91], v[168:171]
    s_waitcnt lgkmcnt(2)
    v_mfma_f32_16x16x32_bf16 v[172:175], v[52:55], v[92:95], v[172:175]
    s_add_u32 s46, s46, 64512
    buffer_load_dwordx4 v23, s[20:23], s46 offen offset:3072 lds
    s_waitcnt lgkmcnt(1)
    v_mfma_f32_16x16x32_bf16 v[176:179], v[52:55], v[96:99], v[176:179]
    s_waitcnt lgkmcnt(0)
    v_mfma_f32_16x16x32_bf16 v[180:183], v[52:55], v[100:103], v[180:183]
    s_mov_b32 m0, s33
    s_add_u32 s34, s34, 1
    buffer_load_dwordx4 v8, s[8:11], s32 offen offset:0 nt lds
    v_mfma_f32_16x16x32_bf16 v[184:187], v[56:59], v[88:91], v[184:187]
    v_mfma_f32_16x16x32_bf16 v[188:191], v[56:59], v[92:95], v[188:191]
    v_mfma_f32_16x16x32_bf16 v[192:195], v[56:59], v[96:99], v[192:195]
    buffer_load_dwordx4 v9, s[8:11], s32 offen offset:1024 nt lds
    s_add_u32 s85, s34, 4
    s_min_u32 s85, s85, 31
    s_max_u32 s85, s85, 0
    v_mfma_f32_16x16x32_bf16 v[196:199], v[56:59], v[100:103], v[196:199]
    v_mfma_f32_16x16x32_bf16 v[200:203], v[60:63], v[88:91], v[200:203]
    s_add_u32 m0, s33, 8192
    s_add_u32 s33, s33, 16384
    buffer_load_dwordx4 v12, s[12:15], s32 offen offset:0 nt lds
    s_and_b32 s84, s85, 15
    s_lshl_b32 s84, s84, 13
    s_lshr_b32 s85, s85, 4
    s_lshl_b32 s85, s85, 18
    v_mfma_f32_16x16x32_bf16 v[204:207], v[60:63], v[92:95], v[204:207]
    v_mfma_f32_16x16x32_bf16 v[208:211], v[60:63], v[96:99], v[208:211]
    v_mfma_f32_16x16x32_bf16 v[212:215], v[60:63], v[100:103], v[212:215]
    buffer_load_dwordx4 v13, s[12:15], s32 offen offset:1024 nt lds
    s_add_u32 s32, s32, 8192
    s_add_u32 s84, s84, s85
    s_add_u32 s84, s84, s87
    v_mfma_f32_16x16x32_bf16 v[216:219], v[64:67], v[88:91], v[216:219]
    v_mfma_f32_16x16x32_bf16 v[220:223], v[64:67], v[92:95], v[220:223]
    s_mov_b64 exec, 1048575
    buffer_load_dword v5, v7, s[72:75], s84 offen offset:1536
    s_mov_b64 exec, -1
    s_cmp_ge_u32 s33, s50
    s_cselect_b32 s55, 98304, 0
    s_sub_u32 s33, s33, s55
    v_mfma_f32_16x16x32_bf16 v[224:227], v[64:67], v[96:99], v[224:227]
    v_mfma_f32_16x16x32_bf16 v[228:231], v[64:67], v[100:103], v[228:231]
    s_add_u32 s44, s44, 1
    s_sub_u32 s46, 9, s44
    s_and_b32 s46, s46, 3
    s_lshl_b32 s46, s46, 13
    v_add_u32 v33, s46, v31
    v_add_u32 v34, s46, v32
    s_sub_u32 s46, s44, 11
    s_cmp_ge_u32 s46, 5
    s_cbranch_scc1 L_q1_nox0
    s_call_b64 s[64:65], F_x
    s_sub_u32 s40, s40, 2
    s_add_u32 s39, s39, 7
    s_sub_u32 s46, s39, 9
    s_cselect_b32 s39, s39, s46
    s_waitcnt vmcnt(7)
    s_branch L_q1_0
L_q1_nox0:
    s_waitcnt vmcnt(5)
    s_cmp_lt_u32 s44, 17
    s_cbranch_scc1 L_q1_0
    s_branch L_q1_last
L_q1_1:
    s_barrier
    ds_read_b64_tr_b16 v[36:37], v24 offset:0
    ds_read_b64_tr_b16 v[38:39], v24 offset:512
    ds_read_b64_tr_b16 v[40:41], v25 offset:0
    ds_read_b64_tr_b16 v[42:43], v25 offset:512
    ds_read_b64_tr_b16 v[44:45], v26 offset:0
    ds_read_b64_tr_b16 v[46:47], v26 offset:512
    ds_read_b64_tr_b16 v[48:49], v27 offset:0
    ds_read_b64_tr_b16 v[50:51], v27 offset:512
    ds_read_b64_tr_b16 v[52:53], v24 offset:4096
    ds_read_b64_tr_b16 v[54:55], v24 offset:4608
    ds_read_b64_tr_b16 v[56:57], v25 offset:4096
    ds_read_b64_tr_b16 v[58:59], v25 offset:4608
    ds_read_b64_tr_b16 v[60:61], v26 offset:4096
    ds_read_b64_tr_b16 v[62:63], v26 offset:4608
    ds_read_b64_tr_b16 v[64:65], v27 offset:4096
    s_waitcnt lgkmcnt(14)
    ds_read_b64_tr_b16 v[66:67], v27 offset:4608
    s_waitcnt lgkmcnt(0)
    s_barrier
    ds_read_b128 v[72:75], v33 offset:0
    ds_read_b128 v[76:79], v33 offset:2048
    ds_read_b128 v[80:83], v33 offset:4096
    ds_read_b128 v[84:87], v33 offset:6144
    ds_read_b128 v[88:91], v34 offset:0
    ds_read_b128 v[92:95], v34 offset:2048
    ds_read_b128 v[96:99], v34 offset:4096
    ds_read_b128 v[100:103], v34 offset:6144
    s_lshl_b32 s46, s36, 19
    s_add_u32 s46, s46, s35
    s_mov_b32 m0, s51
    s_sub_u32 s36, s36, 1
    s_cselect_b32 s36, 8, s36
    buffer_load_dwordx4 v22, s[20:23], s46 offen offset:0 lds
    s_waitcnt lgkmcnt(7)
    v_mfma_f32_16x16x32_bf16 v[168:171], v[36:39], v[72:75], v[168:171]
    s_waitcnt lgkmcnt(6)
    v_mfma_f32_16x16x32_bf16 v[172:175], v[36:39], v[76:79], v[172:175]
    s_add_u32 s46, s46, 64512
    buffer_load_dwordx4 v23, s[20:23], s46 offen offset:1024 lds
    s_waitcnt lgkmcnt(5)
    v_mfma_f32_16x16x32_bf16 v[176:179], v[36:39], v[80:83], v[176:179]
    s_waitcnt lgkmcnt(4)
    v_mfma_f32_16x16x32_bf16 v[180:183], v[36:39], v[84:87], v[180:183]
    s_add_u32 s46, s46, 64512
    buffer_load_dwordx4 v22, s[20:23], s46 offen offset:2048 lds
    v_mfma_f32_16x16x32_bf16 v[184:187], v[40:43], v[72:75], v[184:187]
    v_mfma_f32_16x16x32_bf16 v[188:191], v[40:43], v[76:79], v[188:191]
    s_add_u32 s46, s46, 64512
    buffer_load_dwordx4 v23, s[20:23], s46 offen offset:3072 lds
    v_mfma_f32_16x16x32_bf16 v[192:195], v[40:43], v[80:83], v[192:195]
    v_mfma_f32_16x16x32_bf16 v[196:199], v[40:43], v[84:87], v[196:199]
    s_add_u32 m0, s51, 4096
    s_add_u32 s46, s46, 68608
    buffer_load_dwordx4 v22, s[20:23], s46 offen offset:0 lds
    v_mfma_f32_16x16x32_bf16 v[200:203], v[44:47], v[72:75], v[200:203]
    v_mfma_f32_16x16x32_bf16 v[204:207], v[44:47], v[76:79], v[204:207]
    s_add_u32 s46, s46, 64512
    buffer_load_dwordx4 v23, s[20:23], s46 offen offset:1024 lds
    v_mfma_f32_16x16x32_bf16 v[208:211], v[44:47], v[80:83], v[208:211]
    v_mfma_f32_16x16x32_bf16 v[212:215], v[44:47], v[84:87], v[212:215]
    s_add_u32 s46, s46, 64512
    buffer_load_dwordx4 v22, s[20:23], s46 offen offset:2048 lds
    v_mfma_f32_16x16x32_bf16 v[216:219], v[48:51], v[72:75], v[216:219]
    v_mfma_f32_16x16x32_bf16 v[220:223], v[48:51], v[76:79], v[220:223]
    s_add_u32 s46, s46, 64512
    buffer_load_dwordx4 v23, s[20:23], s46 offen offset:3072 lds
    v_mfma_f32_16x16x32_bf16 v[224:227], v[48:51], v[80:83], v[224:227]
    v_mfma_f32_16x16x32_bf16 v[228:231], v[48:51], v[84:87], v[228:231]
    s_mov_b32 m0, s33
    s_cmp_eq_u32 s34, 15
    buffer_load_dwordx4 v8, s[8:11], s32 offen offset:0 nt lds
    s_cselect_b32 s55, 131072, 0
    s_add_u32 s55, s55, 8192
    s_add_u32 s34, s34, 1
    s_waitcnt lgkmcnt(3)
    v_mfma_f32_16x16x32_bf16 v[168:171], v[52:55], v[88:91], v[168:171]
    s_waitcnt lgkmcnt(2)
    v_mfma_f32_16x16x32_bf16 v[172:175], v[52:55], v[92:95], v[172:175]
    buffer_load_dwordx4 v9, s[8:11], s32 offen offset:1024 nt lds
    s_waitcnt lgkmcnt(1)
    v_mfma_f32_16x16x32_bf16 v[176:179], v[52:55], v[96:99], v[176:179]
    s_waitcnt lgkmcnt(0)
    v_mfma_f32_16x16x32_bf16 v[180:183], v[52:55], v[100:103], v[180:183]
    buffer_load_dwordx4 v10, s[8:11], s32 offen offset:2048 nt lds
    v_mfma_f32_16x16x32_bf16 v[184:187], v[56:59], v[88:91], v[184:187]
    v_mfma_f32_16x16x32_bf16 v[188:191], v[56:59], v[92:95], v[188:191]
    buffer_load_dwordx4 v11, s[8:11], s32 offen offset:3072 nt lds
    v_mfma_f32_16x16x32_bf16 v[192:195], v[56:59], v[96:99], v[192:195]
    v_mfma_f32_16x16x32_bf16 v[196:199], v[56:59], v[100:103], v[196:199]
    s_add_u32 m0, s33, 16384
    s_add_u32 s33, s33, 32768
    buffer_load_dwordx4 v12, s[12:15], s32 offen offset:0 nt lds
    v_mfma_f32_16x16x32_bf16 v[200:203], v[60:63], v[88:91], v[200:203]
    v_mfma_f32_16x16x32_bf16 v[204:207], v[60:63], v[92:95], v[204:207]
    buffer_load_dwordx4 v13, s[12:15], s32 offen offset:1024 nt lds
    v_mfma_f32_16x16x32_bf16 v[208:211], v[60:63], v[96:99], v[208:211]
    v_mfma_f32_16x16x32_bf16 v[212:215], v[60:63], v[100:103], v[212:215]
    buffer_load_dwordx4 v12, s[12:15], s32 offen offset:2048 nt lds
    v_mfma_f32_16x16x32_bf16 v[216:219], v[64:67], v[88:91], v[216:219]
    v_mfma_f32_16x16x32_bf16 v[220:223], v[64:67], v[92:95], v[220:223]
    buffer_load_dwordx4 v13, s[12:15], s32 offen offset:3072 nt lds
    s_add_u32 s32, s32, s55
    s_cmp_ge_u32 s33, s50
    s_cselect_b32 s55, 98304, 0
    s_sub_u32 s33, s33, s55
    v_mfma_f32_16x16x32_bf16 v[224:227], v[64:67], v[96:99], v[224:227]
    v_mfma_f32_16x16x32_bf16 v[228:231], v[64:67], v[100:103], v[228:231]
    s_add_u32 s44, s44, 1
    s_sub_u32 s46, 9, s44
    s_and_b32 s46, s46, 3
    s_lshl_b32 s46, s46, 13
    v_add_u32 v33, s46, v31
    v_add_u32 v34, s46, v32
    s_sub_u32 s46, s44, 11
    s_cmp_ge_u32 s46, 5
    s_cbranch_scc1 L_q1_nox1
    s_call_b64 s[64:65], F_x
    s_sub_u32 s40, s40, 2
    s_add_u32 s39, s39, 7
    s_sub_u32 s46, s39, 9
    s_cselect_b32 s39, s39, s46
    s_waitcnt vmcnt(10)
    s_branch L_q1_1
L_q1_nox1:
    s_waitcnt vmcnt(8)
    s_cmp_lt_u32 s44, 17
    s_cbranch_scc1 L_q1_1
L_q1_last:
    s_barrier
    ds_read_b64_tr_b16 v[36:37], v24 offset:0
    ds_read_b64_tr_b16 v[38:39], v24 offset:512
    ds_read_b64_tr_b16 v[40:41], v25 offset:0
    ds_read_b64_tr_b16 v[42:43], v25 offset:512
    ds_read_b64_tr_b16 v[44:45], v26 offset:0
    ds_read_b64_tr_b16 v[46:47], v26 offset:512
    ds_read_b64_tr_b16 v[48:49], v27 offset:0
    ds_read_b64_tr_b16 v[50:51], v27 offset:512
    ds_read_b64_tr_b16 v[52:53], v24 offset:4096
    ds_read_b64_tr_b16 v[54:55], v24 offset:4608
    ds_read_b64_tr_b16 v[56:57], v25 offset:4096
    ds_read_b64_tr_b16 v[58:59], v25 offset:4608
    ds_read_b64_tr_b16 v[60:61], v26 offset:4096
    ds_read_b64_tr_b16 v[62:63], v26 offset:4608
    ds_read_b64_tr_b16 v[64:65], v27 offset:4096
    s_waitcnt lgkmcnt(14)
    ds_read_b64_tr_b16 v[66:67], v27 offset:4608
    s_waitcnt lgkmcnt(0)
    s_barrier
    ds_read_b128 v[72:75], v33 offset:0
    ds_read_b128 v[76:79], v33 offset:2048
    ds_read_b128 v[80:83], v33 offset:4096
    ds_read_b128 v[84:87], v33 offset:6144
    ds_read_b128 v[88:91], v34 offset:0
    ds_read_b128 v[92:95], v34 offset:2048
    ds_read_b128 v[96:99], v34 offset:4096
    ds_read_b128 v[100:103], v34 offset:6144
    s_call_b64 s[64:65], F_kv
    s_waitcnt lgkmcnt(0)
    s_mov_b32 s48, 0x3e0293ee
    v_mfma_f32_16x16x32_bf16 v[168:171], v[36:39], v[72:75], v[168:171]
    v_mfma_f32_16x16x32_bf16 v[172:175], v[36:39], v[76:79], v[172:175]
    v_mfma_f32_16x16x32_bf16 v[176:179], v[36:39], v[80:83], v[176:179]
    v_mfma_f32_16x16x32_bf16 v[180:183], v[36:39], v[84:87], v[180:183]
    v_mfma_f32_16x16x32_bf16 v[184:187], v[40:43], v[72:75], v[184:187]
    v_mfma_f32_16x16x32_bf16 v[188:191], v[40:43], v[76:79], v[188:191]
    v_mfma_f32_16x16x32_bf16 v[192:195], v[40:43], v[80:83], v[192:195]
    v_mfma_f32_16x16x32_bf16 v[196:199], v[40:43], v[84:87], v[196:199]
    v_mfma_f32_16x16x32_bf16 v[200:203], v[44:47], v[72:75], v[200:203]
    v_mfma_f32_16x16x32_bf16 v[204:207], v[44:47], v[76:79], v[204:207]
    v_mfma_f32_16x16x32_bf16 v[208:211], v[44:47], v[80:83], v[208:211]
    v_mfma_f32_16x16x32_bf16 v[212:215], v[44:47], v[84:87], v[212:215]
    v_mfma_f32_16x16x32_bf16 v[216:219], v[48:51], v[72:75], v[216:219]
    v_mfma_f32_16x16x32_bf16 v[220:223], v[48:51], v[76:79], v[220:223]
    v_mfma_f32_16x16x32_bf16 v[224:227], v[48:51], v[80:83], v[224:227]
    v_mfma_f32_16x16x32_bf16 v[228:231], v[48:51], v[84:87], v[228:231]
    v_mfma_f32_16x16x32_bf16 v[168:171], v[52:55], v[88:91], v[168:171]
    v_mfma_f32_16x16x32_bf16 v[172:175], v[52:55], v[92:95], v[172:175]
    v_mfma_f32_16x16x32_bf16 v[176:179], v[52:55], v[96:99], v[176:179]
    v_mfma_f32_16x16x32_bf16 v[180:183], v[52:55], v[100:103], v[180:183]
    v_mfma_f32_16x16x32_bf16 v[184:187], v[56:59], v[88:91], v[184:187]
    s_nop 3
    v_mul_f32 v168, s48, v168
    v_mul_f32 v169, s48, v169
    v_mul_f32 v170, s48, v170
    v_mul_f32 v171, s48, v171
    v_mfma_f32_16x16x32_bf16 v[188:191], v[56:59], v[92:95], v[188:191]
    v_cvt_pk_bf16_f32 v168, v168, v169
    v_cvt_pk_bf16_f32 v169, v170, v171
    v_mul_f32 v172, s48, v172
    v_mul_f32 v173, s48, v173
    v_mul_f32 v174, s48, v174
    v_mul_f32 v175, s48, v175
    v_mfma_f32_16x16x32_bf16 v[192:195], v[56:59], v[96:99], v[192:195]
    v_xor_b32 v1, 0, v29
    ds_write_b64 v1, v[168:169] offset:0
    v_cvt_pk_bf16_f32 v172, v172, v173
    v_cvt_pk_bf16_f32 v173, v174, v175
    v_mul_f32 v176, s48, v176
    v_mul_f32 v177, s48, v177
    v_mul_f32 v178, s48, v178
    v_mul_f32 v179, s48, v179
    v_mfma_f32_16x16x32_bf16 v[196:199], v[56:59], v[100:103], v[196:199]
    ds_write_b64 v1, v[172:173] offset:2048
    v_cvt_pk_bf16_f32 v176, v176, v177
    v_cvt_pk_bf16_f32 v177, v178, v179
    v_mul_f32 v180, s48, v180
    v_mul_f32 v181, s48, v181
    v_mul_f32 v182, s48, v182
    v_mul_f32 v183, s48, v183
    v_mfma_f32_16x16x32_bf16 v[200:203], v[60:63], v[88:91], v[200:203]
    ds_write_b64 v1, v[176:177] offset:4096
    v_cvt_pk_bf16_f32 v180, v180, v181
    v_cvt_pk_bf16_f32 v181, v182, v183
    v_mul_f32 v184, s48, v184
    v_mul_f32 v185, s48, v185
    v_mul_f32 v186, s48, v186
    v_mul_f32 v187, s48, v187
    v_mfma_f32_16x16x32_bf16 v[204:207], v[60:63], v[92:95], v[204:207]
    ds_write_b64 v1, v[180:181] offset:6144
    v_cvt_pk_bf16_f32 v184, v184, v185
    v_cvt_pk_bf16_f32 v185, v186, v187
    v_mul_f32 v188, s48, v188
    v_mul_f32 v189, s48, v189
    v_mul_f32 v190, s48, v190
    v_mul_f32 v191, s48, v191
    v_mfma_f32_16x16x32_bf16 v[208:211], v[60:63], v[96:99], v[208:211]
    v_xor_b32 v1, 32, v29
    ds_write_b64 v1, v[184:185] offset:0
    v_cvt_pk_bf16_f32 v188, v188, v189
    v_cvt_pk_bf16_f32 v189, v190, v191
    v_mul_f32 v192, s48, v192
    v_mul_f32 v193, s48, v193
    v_mul_f32 v194, s48, v194
    v_mul_f32 v195, s48, v195
    v_mfma_f32_16x16x32_bf16 v[212:215], v[60:63], v[100:103], v[212:215]
    ds_write_b64 v1, v[188:189] offset:2048
    v_cvt_pk_bf16_f32 v192, v192, v193
    v_cvt_pk_bf16_f32 v193, v194, v195
    v_mul_f32 v196, s48, v196
    v_mul_f32 v197, s48, v197
    v_mul_f32 v198, s48, v198
    v_mul_f32 v199, s48, v199
    v_mfma_f32_16x16x32_bf16 v[216:219], v[64:67], v[88:91], v[216:219]
    ds_write_b64 v1, v[192:193] offset:4096
    v_cvt_pk_bf16_f32 v196, v196, v197
    v_cvt_pk_bf16_f32 v197, v198, v199
    v_mul_f32 v200, s48, v200
    v_mul_f32 v201, s48, v201
    v_mul_f32 v202, s48, v202
    v_mul_f32 v203, s48, v203
    v_mfma_f32_16x16x32_bf16 v[220:223], v[64:67], v[92:95], v[220:223]
    ds_write_b64 v1, v[196:197] offset:6144
    v_cvt_pk_bf16_f32 v200, v200, v201
    v_cvt_pk_bf16_f32 v201, v202, v203
    v_mul_f32 v204, s48, v204
    v_mul_f32 v205, s48, v205
    v_mul_f32 v206, s48, v206
    v_mul_f32 v207, s48, v207
    v_mfma_f32_16x16x32_bf16 v[224:227], v[64:67], v[96:99], v[224:227]
    v_xor_b32 v1, 64, v29
    ds_write_b64 v1, v[200:201] offset:0
    v_cvt_pk_bf16_f32 v204, v204, v205
    v_cvt_pk_bf16_f32 v205, v206, v207
    v_mul_f32 v208, s48, v208
    v_mul_f32 v209, s48, v209
    v_mul_f32 v210, s48, v210
    v_mul_f32 v211, s48, v211
    v_mfma_f32_16x16x32_bf16 v[228:231], v[64:67], v[100:103], v[228:231]
    ds_write_b64 v1, v[204:205] offset:2048
    v_cvt_pk_bf16_f32 v208, v208, v209
    v_cvt_pk_bf16_f32 v209, v210, v211
    v_mul_f32 v212, s48, v212
    v_mul_f32 v213, s48, v213
    v_mul_f32 v214, s48, v214
    v_mul_f32 v215, s48, v215
    ds_write_b64 v1, v[208:209] offset:4096
    v_cvt_pk_bf16_f32 v212, v212, v213
    v_cvt_pk_bf16_f32 v213, v214, v215
    v_mul_f32 v216, s48, v216
    v_mul_f32 v217, s48, v217
    v_mul_f32 v218, s48, v218
    v_mul_f32 v219, s48, v219
    ds_write_b64 v1, v[212:213] offset:6144
    v_cvt_pk_bf16_f32 v216, v216, v217
    v_cvt_pk_bf16_f32 v217, v218, v219
    v_mul_f32 v220, s48, v220
    v_mul_f32 v221, s48, v221
    v_mul_f32 v222, s48, v222
    v_mul_f32 v223, s48, v223
    v_xor_b32 v1, 96, v29
    ds_write_b64 v1, v[216:217] offset:0
    v_cvt_pk_bf16_f32 v220, v220, v221
    v_cvt_pk_bf16_f32 v221, v222, v223
    v_mul_f32 v224, s48, v224
    v_mul_f32 v225, s48, v225
    v_mul_f32 v226, s48, v226
    v_mul_f32 v227, s48, v227
    ds_write_b64 v1, v[220:221] offset:2048
    v_cvt_pk_bf16_f32 v224, v224, v225
    v_cvt_pk_bf16_f32 v225, v226, v227
    v_mul_f32 v228, s48, v228
    v_mul_f32 v229, s48, v229
    v_mul_f32 v230, s48, v230
    v_mul_f32 v231, s48, v231
    ds_write_b64 v1, v[224:225] offset:4096
    v_cvt_pk_bf16_f32 v228, v228, v229
    v_cvt_pk_bf16_f32 v229, v230, v231
    ds_write_b64 v1, v[228:229] offset:6144
    s_waitcnt lgkmcnt(0)
    s_waitcnt vmcnt(8)
    s_cmp_eq_u32 s55, 8
    s_cbranch_scc1 L_kw3
    s_waitcnt vmcnt(5)
    s_cmp_eq_u32 s55, 4
    s_cbranch_scc1 L_kw3
    s_waitcnt vmcnt(0)
L_kw3:
    s_barrier
    s_barrier
    s_call_b64 s[64:65], F_kv
    v_mov_b32 v104, 0
    v_mov_b32 v105, 0
    v_mov_b32 v106, 0
    v_mov_b32 v107, 0
    v_mov_b32 v108, 0
    v_mov_b32 v109, 0
    v_mov_b32 v110, 0
    v_mov_b32 v111, 0
    v_mov_b32 v112, 0
    v_mov_b32 v113, 0
    v_mov_b32 v114, 0
    v_mov_b32 v115, 0
    v_mov_b32 v116, 0
    v_mov_b32 v117, 0
    v_mov_b32 v118, 0
    v_mov_b32 v119, 0
    v_mov_b32 v120, 0
    v_mov_b32 v121, 0
    v_mov_b32 v122, 0
    v_mov_b32 v123, 0
    v_mov_b32 v124, 0
    v_mov_b32 v125, 0
    v_mov_b32 v126, 0
    v_mov_b32 v127, 0
    v_mov_b32 v128, 0
    v_mov_b32 v129, 0
    v_mov_b32 v130, 0
    v_mov_b32 v131, 0
    v_mov_b32 v132, 0
    v_mov_b32 v133, 0
    v_mov_b32 v134, 0
    v_mov_b32 v135, 0
    v_mov_b32 v136, 0
    v_mov_b32 v137, 0
    v_mov_b32 v138, 0
    v_mov_b32 v139, 0
    v_mov_b32 v140, 0
    v_mov_b32 v141, 0
    v_mov_b32 v142, 0
    v_mov_b32 v143, 0
    v_mov_b32 v144, 0
    v_mov_b32 v145, 0
    v_mov_b32 v146, 0
    v_mov_b32 v147, 0
    v_mov_b32 v148, 0
    v_mov_b32 v149, 0
    v_mov_b32 v150, 0
    v_mov_b32 v151, 0
    v_mov_b32 v152, 0
    v_mov_b32 v153, 0
    v_mov_b32 v154, 0
    v_mov_b32 v155, 0
    v_mov_b32 v156, 0
    v_mov_b32 v157, 0
    v_mov_b32 v158, 0
    v_mov_b32 v159, 0
    v_mov_b32 v160, 0
    v_mov_b32 v161, 0
    v_mov_b32 v162, 0
    v_mov_b32 v163, 0
    v_mov_b32 v164, 0
    v_mov_b32 v165, 0
    v_mov_b32 v166, 0
    v_mov_b32 v167, 0
    v_mov_b32 v168, 0
    v_mov_b32 v169, 0
    v_mov_b32 v170, 0
    v_mov_b32 v171, 0
    v_mov_b32 v172, 0
    v_mov_b32 v173, 0
    v_mov_b32 v174, 0
    v_mov_b32 v175, 0
    v_mov_b32 v176, 0
    v_mov_b32 v177, 0
    v_mov_b32 v178, 0
    v_mov_b32 v179, 0
    v_mov_b32 v180, 0
    v_mov_b32 v181, 0
    v_mov_b32 v182, 0
    v_mov_b32 v183, 0
    v_mov_b32 v184, 0
    v_mov_b32 v185, 0
    v_mov_b32 v186, 0
    v_mov_b32 v187, 0
    v_mov_b32 v188, 0
    v_mov_b32 v189, 0
    v_mov_b32 v190, 0
    v_mov_b32 v191, 0
    v_mov_b32 v192, 0
    v_mov_b32 v193, 0
    v_mov_b32 v194, 0
    v_mov_b32 v195, 0
    v_mov_b32 v196, 0
    v_mov_b32 v197, 0
    v_mov_b32 v198, 0
    v_mov_b32 v199, 0
    v_mov_b32 v200, 0
    v_mov_b32 v201, 0
    v_mov_b32 v202, 0
    v_mov_b32 v203, 0
    v_mov_b32 v204, 0
    v_mov_b32 v205, 0
    v_mov_b32 v206, 0
    v_mov_b32 v207, 0
    v_mov_b32 v208, 0
    v_mov_b32 v209, 0
    v_mov_b32 v210, 0
    v_mov_b32 v211, 0
    v_mov_b32 v212, 0
    v_mov_b32 v213, 0
    v_mov_b32 v214, 0
    v_mov_b32 v215, 0
    v_mov_b32 v216, 0
    v_mov_b32 v217, 0
    v_mov_b32 v218, 0
    v_mov_b32 v219, 0
    v_mov_b32 v220, 0
    v_mov_b32 v221, 0
    v_mov_b32 v222, 0
    v_mov_b32 v223, 0
    v_mov_b32 v224, 0
    v_mov_b32 v225, 0
    v_mov_b32 v226, 0
    v_mov_b32 v227, 0
    v_mov_b32 v228, 0
    v_mov_b32 v229, 0
    v_mov_b32 v230, 0
    v_mov_b32 v231, 0
    v_mov_b32 v232, 0
    v_mov_b32 v233, 0
    v_mov_b32 v234, 0
    v_mov_b32 v235, 0
    v_mov_b32 v236, 0
    v_mov_b32 v237, 0
    v_mov_b32 v238, 0
    v_mov_b32 v239, 0
    v_mov_b32 v240, 0
    v_mov_b32 v241, 0
    v_mov_b32 v242, 0
    v_mov_b32 v243, 0
    v_mov_b32 v244, 0
    v_mov_b32 v245, 0
    v_mov_b32 v246, 0
    v_mov_b32 v247, 0
    v_lshrrev_b32 v6, 2, v0
    v_bfe_u32 v1, v6, 1, 2
    v_and_b32 v7, 3, v0
    v_lshlrev_b32 v7, 3, v7
    v_mul_u32_u24 v6, 384, v6
    v_add_u32 v6, v6, v7
    s_mul_i32 s46, s4, 3
    s_add_u32 s47, s46, 0
    v_xor_b32 v7, s47, v1
    v_lshl_add_u32 v24, v7, 5, v6
    v_add_u32 v27, 98304, v24
    s_add_u32 s47, s46, 1
    v_xor_b32 v7, s47, v1
    v_lshl_add_u32 v25, v7, 5, v6
    v_add_u32 v28, 98304, v25
    s_add_u32 s47, s46, 2
    v_xor_b32 v7, s47, v1
    v_lshl_add_u32 v26, v7, 5, v6
    v_add_u32 v29, 98304, v26
    s_lshl_b32 s46, s6, 4
    s_add_u32 s46, s46, s7
    s_lshl_b32 s46, s46, 3
    s_add_u32 s46, s46, s5
    s_mul_i32 s45, s46, 73728
    s_add_u32 s45, s45, s52
    v_lshl_add_u32 v30, v3, 2, v2
    v_lshlrev_b32 v30, 4, v30
    s_waitcnt vmcnt(8)
    s_cmp_eq_u32 s55, 8
    s_cbranch_scc1 L_kw4
    s_waitcnt vmcnt(5)
    s_cmp_eq_u32 s55, 4
    s_cbranch_scc1 L_kw4
    s_waitcnt vmcnt(0)
L_kw4:
    s_mov_b32 s44, 6
L_kvl:
    s_barrier
    s_barrier
    s_call_b64 s[64:65], F_kv
    s_waitcnt vmcnt(8)
    s_cmp_eq_u32 s55, 8
    s_cbranch_scc1 L_kw5
    s_waitcnt vmcnt(5)
    s_cmp_eq_u32 s55, 4
    s_cbranch_scc1 L_kw5
    s_waitcnt vmcnt(0)
L_kw5:
    s_sub_u32 s44, s44, 1
    s_cmp_lg_u32 s44, 0
    s_cbranch_scc1 L_kvl
L_kvl_done:
    s_barrier
    s_barrier
    s_call_b64 s[64:65], F_wo
    s_call_b64 s[64:65], F_kv
    s_waitcnt vmcnt(8)
    s_cmp_eq_u32 s55, 8
    s_cbranch_scc1 L_kw6
    s_waitcnt vmcnt(5)
    s_cmp_eq_u32 s55, 4
    s_cbranch_scc1 L_kw6
    s_waitcnt vmcnt(0)
L_kw6:
    s_mov_b32 s44, -1
    v_lshlrev_b32 v7, 7, v0
    s_add_u32 s44, s44, 1
    s_add_u32 s46, s43, s44
    s_and_b32 s46, s46, 3
    s_lshl_b32 s46, s46, 13
    v_add_u32 v33, s46, v31
    v_add_u32 v34, s46, v32
    s_cmp_eq_u32 s6, 1
    s_cbranch_scc1 L_o2_1
L_o2_0:
    s_barrier
    ds_read_b64_tr_b16 v[36:37], v27 offset:0
    ds_read_b64_tr_b16 v[38:39], v27 offset:6144
    ds_read_b64_tr_b16 v[40:41], v28 offset:0
    ds_read_b64_tr_b16 v[42:43], v28 offset:6144
    ds_read_b64_tr_b16 v[44:45], v29 offset:0
    ds_read_b64_tr_b16 v[46:47], v29 offset:6144
    ds_read_b64_tr_b16 v[48:49], v27 offset:12288
    ds_read_b64_tr_b16 v[50:51], v27 offset:18432
    ds_read_b64_tr_b16 v[52:53], v28 offset:12288
    ds_read_b64_tr_b16 v[54:55], v28 offset:18432
    ds_read_b64_tr_b16 v[56:57], v29 offset:12288
    ds_read_b64_tr_b16 v[58:59], v29 offset:18432
    s_waitcnt lgkmcnt(0)
    s_barrier
    ds_read_b128 v[72:75], v33 offset:0
    ds_read_b128 v[76:79], v33 offset:2048
    ds_read_b128 v[80:83], v33 offset:4096
    ds_read_b128 v[84:87], v33 offset:6144
    ds_read_b128 v[88:91], v34 offset:0
    ds_read_b128 v[92:95], v34 offset:2048
    ds_read_b128 v[96:99], v34 offset:4096
    ds_read_b128 v[100:103], v34 offset:6144
    s_add_u32 s46, s41, s43
    s_and_b32 s46, s46, 3
    s_lshr_b32 s47, s41, 2
    s_lshl_b32 s47, s47, 2
    s_add_u32 s46, s46, s47
    s_mul_i32 s46, s46, 73728
    s_add_u32 s46, s46, s91
    s_add_u32 s47, s53, s52
    s_mov_b32 m0, s47
    s_add_u32 s46, s46, s42
    buffer_load_dwordx4 v16, s[24:27], s46 offen offset:0 lds
    s_waitcnt lgkmcnt(7)
    v_mfma_f32_16x16x32_bf16 v[104:107], v[36:39], v[72:75], v[104:107]
    s_waitcnt lgkmcnt(6)
    v_mfma_f32_16x16x32_bf16 v[108:111], v[36:39], v[76:79], v[108:111]
    s_waitcnt lgkmcnt(5)
    v_mfma_f32_16x16x32_bf16 v[112:115], v[36:39], v[80:83], v[112:115]
    buffer_load_dwordx4 v17, s[24:27], s46 offen offset:1024 lds
    s_waitcnt lgkmcnt(4)
    v_mfma_f32_16x16x32_bf16 v[116:119], v[36:39], v[84:87], v[116:119]
    v_mfma_f32_16x16x32_bf16 v[120:123], v[40:43], v[72:75], v[120:123]
    buffer_load_dwordx4 v18, s[24:27], s46 offen offset:2048 lds
    v_mfma_f32_16x16x32_bf16 v[124:127], v[40:43], v[76:79], v[124:127]
    v_mfma_f32_16x16x32_bf16 v[128:131], v[40:43], v[80:83], v[128:131]
    buffer_load_dwordx4 v19, s[24:27], s46 offen offset:3072 lds
    v_mfma_f32_16x16x32_bf16 v[132:135], v[40:43], v[84:87], v[132:135]
    v_mfma_f32_16x16x32_bf16 v[136:139], v[44:47], v[72:75], v[136:139]
    s_add_u32 m0, s47, 4096
    s_nop 0
    buffer_load_dwordx4 v20, s[24:27], s46 offen offset:0 lds
    v_mfma_f32_16x16x32_bf16 v[140:143], v[44:47], v[76:79], v[140:143]
    v_mfma_f32_16x16x32_bf16 v[144:147], v[44:47], v[80:83], v[144:147]
    buffer_load_dwordx4 v21, s[24:27], s46 offen offset:1024 lds
    s_add_u32 s91, s91, 384
    s_cmp_eq_u32 s91, 1152
    s_cselect_b32 s91, 0, s91
    s_addc_u32 s41, s41, 0
    v_mfma_f32_16x16x32_bf16 v[148:151], v[44:47], v[84:87], v[148:151]
    s_waitcnt lgkmcnt(3)
    v_mfma_f32_16x16x32_bf16 v[104:107], v[48:51], v[88:91], v[104:107]
    s_waitcnt lgkmcnt(2)
    v_mfma_f32_16x16x32_bf16 v[108:111], v[48:51], v[92:95], v[108:111]
    s_mov_b32 m0, s33
    s_add_u32 s34, s34, 1
    buffer_load_dwordx4 v8, s[8:11], s32 offen offset:0 nt lds
    s_waitcnt lgkmcnt(1)
    v_mfma_f32_16x16x32_bf16 v[112:115], v[48:51], v[96:99], v[112:115]
    s_waitcnt lgkmcnt(0)
    v_mfma_f32_16x16x32_bf16 v[116:119], v[48:51], v[100:103], v[116:119]
    buffer_load_dwordx4 v9, s[8:11], s32 offen offset:1024 nt lds
    s_add_u32 s85, s34, 4
    s_min_u32 s85, s85, 31
    s_max_u32 s85, s85, 0
    v_mfma_f32_16x16x32_bf16 v[120:123], v[52:55], v[88:91], v[120:123]
    v_mfma_f32_16x16x32_bf16 v[124:127], v[52:55], v[92:95], v[124:127]
    s_add_u32 m0, s33, 8192
    s_add_u32 s33, s33, 16384
    buffer_load_dwordx4 v12, s[12:15], s32 offen offset:0 nt lds
    s_and_b32 s84, s85, 15
    s_lshl_b32 s84, s84, 13
    s_lshr_b32 s85, s85, 4
    s_lshl_b32 s85, s85, 18
    v_mfma_f32_16x16x32_bf16 v[128:131], v[52:55], v[96:99], v[128:131]
    v_mfma_f32_16x16x32_bf16 v[132:135], v[52:55], v[100:103], v[132:135]
    buffer_load_dwordx4 v13, s[12:15], s32 offen offset:1024 nt lds
    s_add_u32 s32, s32, 8192
    s_add_u32 s84, s84, s85
    s_add_u32 s84, s84, s87
    v_mfma_f32_16x16x32_bf16 v[136:139], v[56:59], v[88:91], v[136:139]
    v_mfma_f32_16x16x32_bf16 v[140:143], v[56:59], v[92:95], v[140:143]
    s_mov_b64 exec, 1048575
    buffer_load_dword v5, v7, s[72:75], s84 offen offset:1536
    s_mov_b64 exec, -1
    s_cmp_ge_u32 s33, s50
    s_cselect_b32 s55, 98304, 0
    s_sub_u32 s33, s33, s55
    v_mfma_f32_16x16x32_bf16 v[144:147], v[56:59], v[96:99], v[144:147]
    v_mfma_f32_16x16x32_bf16 v[148:151], v[56:59], v[100:103], v[148:151]
    s_add_u32 s44, s44, 1
    s_add_u32 s46, s43, s44
    s_and_b32 s46, s46, 3
    s_lshl_b32 s46, s46, 13
    v_add_u32 v33, s46, v31
    v_add_u32 v34, s46, v32
    s_waitcnt vmcnt(5)
    s_barrier
    ds_read_b64_tr_b16 v[36:37], v27 offset:0
    ds_read_b64_tr_b16 v[38:39], v27 offset:6144
    ds_read_b64_tr_b16 v[40:41], v28 offset:0
    ds_read_b64_tr_b16 v[42:43], v28 offset:6144
    ds_read_b64_tr_b16 v[44:45], v29 offset:0
    ds_read_b64_tr_b16 v[46:47], v29 offset:6144
    ds_read_b64_tr_b16 v[48:49], v27 offset:12288
    ds_read_b64_tr_b16 v[50:51], v27 offset:18432
    ds_read_b64_tr_b16 v[52:53], v28 offset:12288
    ds_read_b64_tr_b16 v[54:55], v28 offset:18432
    ds_read_b64_tr_b16 v[56:57], v29 offset:12288
    ds_read_b64_tr_b16 v[58:59], v29 offset:18432
    s_waitcnt lgkmcnt(0)
    s_barrier
    s_add_u32 s46, s41, s43
    s_and_b32 s46, s46, 3
    s_lshr_b32 s47, s41, 2
    s_lshl_b32 s47, s47, 2
    s_add_u32 s46, s46, s47
    s_mul_i32 s46, s46, 73728
    s_add_u32 s46, s46, s91
    s_add_u32 s47, s53, s52
    s_mov_b32 m0, s47
    s_add_u32 s46, s46, s42
    buffer_load_dwordx4 v16, s[24:27], s46 offen offset:0 lds
    v_mfma_f32_16x16x32_bf16 v[152:155], v[36:39], v[72:75], v[152:155]
    v_mfma_f32_16x16x32_bf16 v[156:159], v[36:39], v[76:79], v[156:159]
    v_mfma_f32_16x16x32_bf16 v[160:163], v[36:39], v[80:83], v[160:163]
    buffer_load_dwordx4 v17, s[24:27], s46 offen offset:1024 lds
    v_mfma_f32_16x16x32_bf16 v[164:167], v[36:39], v[84:87], v[164:167]
    v_mfma_f32_16x16x32_bf16 v[168:171], v[40:43], v[72:75], v[168:171]
    buffer_load_dwordx4 v18, s[24:27], s46 offen offset:2048 lds
    v_mfma_f32_16x16x32_bf16 v[172:175], v[40:43], v[76:79], v[172:175]
    v_mfma_f32_16x16x32_bf16 v[176:179], v[40:43], v[80:83], v[176:179]
    buffer_load_dwordx4 v19, s[24:27], s46 offen offset:3072 lds
    v_mfma_f32_16x16x32_bf16 v[180:183], v[40:43], v[84:87], v[180:183]
    v_mfma_f32_16x16x32_bf16 v[184:187], v[44:47], v[72:75], v[184:187]
    s_add_u32 m0, s47, 4096
    s_nop 0
    buffer_load_dwordx4 v20, s[24:27], s46 offen offset:0 lds
    v_mfma_f32_16x16x32_bf16 v[188:191], v[44:47], v[76:79], v[188:191]
    v_mfma_f32_16x16x32_bf16 v[192:195], v[44:47], v[80:83], v[192:195]
    buffer_load_dwordx4 v21, s[24:27], s46 offen offset:1024 lds
    s_add_u32 s91, s91, 384
    s_cmp_eq_u32 s91, 1152
    s_cselect_b32 s91, 0, s91
    s_addc_u32 s41, s41, 0
    v_mfma_f32_16x16x32_bf16 v[196:199], v[44:47], v[84:87], v[196:199]
    v_mfma_f32_16x16x32_bf16 v[152:155], v[48:51], v[88:91], v[152:155]
    v_mfma_f32_16x16x32_bf16 v[156:159], v[48:51], v[92:95], v[156:159]
    s_mov_b32 m0, s33
    s_add_u32 s34, s34, 1
    buffer_load_dwordx4 v8, s[8:11], s32 offen offset:0 nt lds
    v_mfma_f32_16x16x32_bf16 v[160:163], v[48:51], v[96:99], v[160:163]
    v_mfma_f32_16x16x32_bf16 v[164:167], v[48:51], v[100:103], v[164:167]
    buffer_load_dwordx4 v9, s[8:11], s32 offen offset:1024 nt lds
    s_add_u32 s85, s34, 4
    s_min_u32 s85, s85, 31
    s_max_u32 s85, s85, 0
    v_mfma_f32_16x16x32_bf16 v[168:171], v[52:55], v[88:91], v[168:171]
    v_mfma_f32_16x16x32_bf16 v[172:175], v[52:55], v[92:95], v[172:175]
    s_add_u32 m0, s33, 8192
    s_add_u32 s33, s33, 16384
    buffer_load_dwordx4 v12, s[12:15], s32 offen offset:0 nt lds
    s_and_b32 s84, s85, 15
    s_lshl_b32 s84, s84, 13
    s_lshr_b32 s85, s85, 4
    s_lshl_b32 s85, s85, 18
    v_mfma_f32_16x16x32_bf16 v[176:179], v[52:55], v[96:99], v[176:179]
    v_mfma_f32_16x16x32_bf16 v[180:183], v[52:55], v[100:103], v[180:183]
    buffer_load_dwordx4 v13, s[12:15], s32 offen offset:1024 nt lds
    s_add_u32 s32, s32, 8192
    s_add_u32 s84, s84, s85
    s_add_u32 s84, s84, s87
    v_mfma_f32_16x16x32_bf16 v[184:187], v[56:59], v[88:91], v[184:187]
    v_mfma_f32_16x16x32_bf16 v[188:191], v[56:59], v[92:95], v[188:191]
    s_mov_b64 exec, 1048575
    buffer_load_dword v5, v7, s[72:75], s84 offen offset:1536
    s_mov_b64 exec, -1
    s_cmp_ge_u32 s33, s50
    s_cselect_b32 s55, 98304, 0
    s_sub_u32 s33, s33, s55
    v_mfma_f32_16x16x32_bf16 v[192:195], v[56:59], v[96:99], v[192:195]
    v_mfma_f32_16x16x32_bf16 v[196:199], v[56:59], v[100:103], v[196:199]
    s_waitcnt vmcnt(5)
    s_barrier
    ds_read_b64_tr_b16 v[36:37], v27 offset:0
    ds_read_b64_tr_b16 v[38:39], v27 offset:6144
    ds_read_b64_tr_b16 v[40:41], v28 offset:0
    ds_read_b64_tr_b16 v[42:43], v28 offset:6144
    ds_read_b64_tr_b16 v[44:45], v29 offset:0
    ds_read_b64_tr_b16 v[46:47], v29 offset:6144
    ds_read_b64_tr_b16 v[48:49], v27 offset:12288
    ds_read_b64_tr_b16 v[50:51], v27 offset:18432
    ds_read_b64_tr_b16 v[52:53], v28 offset:12288
    ds_read_b64_tr_b16 v[54:55], v28 offset:18432
    ds_read_b64_tr_b16 v[56:57], v29 offset:12288
    ds_read_b64_tr_b16 v[58:59], v29 offset:18432
    s_waitcnt lgkmcnt(0)
    s_barrier
    s_add_u32 s46, s41, s43
    s_and_b32 s46, s46, 3
    s_lshr_b32 s47, s41, 2
    s_lshl_b32 s47, s47, 2
    s_add_u32 s46, s46, s47
    s_mul_i32 s46, s46, 73728
    s_add_u32 s46, s46, s91
    s_add_u32 s47, s53, s52
    s_mov_b32 m0, s47
    s_add_u32 s46, s46, s42
    buffer_load_dwordx4 v16, s[24:27], s46 offen offset:0 lds
    v_mfma_f32_16x16x32_bf16 v[200:203], v[36:39], v[72:75], v[200:203]
    v_mfma_f32_16x16x32_bf16 v[204:207], v[36:39], v[76:79], v[204:207]
    v_mfma_f32_16x16x32_bf16 v[208:211], v[36:39], v[80:83], v[208:211]
    buffer_load_dwordx4 v17, s[24:27], s46 offen offset:1024 lds
    v_mfma_f32_16x16x32_bf16 v[212:215], v[36:39], v[84:87], v[212:215]
    v_mfma_f32_16x16x32_bf16 v[216:219], v[40:43], v[72:75], v[216:219]
    buffer_load_dwordx4 v18, s[24:27], s46 offen offset:2048 lds
    v_mfma_f32_16x16x32_bf16 v[220:223], v[40:43], v[76:79], v[220:223]
    v_mfma_f32_16x16x32_bf16 v[224:227], v[40:43], v[80:83], v[224:227]
    buffer_load_dwordx4 v19, s[24:27], s46 offen offset:3072 lds
    v_mfma_f32_16x16x32_bf16 v[228:231], v[40:43], v[84:87], v[228:231]
    v_mfma_f32_16x16x32_bf16 v[232:235], v[44:47], v[72:75], v[232:235]
    s_add_u32 m0, s47, 4096
    s_nop 0
    buffer_load_dwordx4 v20, s[24:27], s46 offen offset:0 lds
    v_mfma_f32_16x16x32_bf16 v[236:239], v[44:47], v[76:79], v[236:239]
    v_mfma_f32_16x16x32_bf16 v[240:243], v[44:47], v[80:83], v[240:243]
    buffer_load_dwordx4 v21, s[24:27], s46 offen offset:1024 lds
    s_add_u32 s91, s91, 384
    s_cmp_eq_u32 s91, 1152
    s_cselect_b32 s91, 0, s91
    s_addc_u32 s41, s41, 0
    v_mfma_f32_16x16x32_bf16 v[244:247], v[44:47], v[84:87], v[244:247]
    v_mfma_f32_16x16x32_bf16 v[200:203], v[48:51], v[88:91], v[200:203]
    v_mfma_f32_16x16x32_bf16 v[204:207], v[48:51], v[92:95], v[204:207]
    s_mov_b32 m0, s33
    s_add_u32 s34, s34, 1
    buffer_load_dwordx4 v8, s[8:11], s32 offen offset:0 nt lds
    v_mfma_f32_16x16x32_bf16 v[208:211], v[48:51], v[96:99], v[208:211]
    v_mfma_f32_16x16x32_bf16 v[212:215], v[48:51], v[100:103], v[212:215]
    buffer_load_dwordx4 v9, s[8:11], s32 offen offset:1024 nt lds
    s_add_u32 s85, s34, 4
    s_min_u32 s85, s85, 31
    s_max_u32 s85, s85, 0
    v_mfma_f32_16x16x32_bf16 v[216:219], v[52:55], v[88:91], v[216:219]
    v_mfma_f32_16x16x32_bf16 v[220:223], v[52:55], v[92:95], v[220:223]
    s_add_u32 m0, s33, 8192
    s_add_u32 s33, s33, 16384
    buffer_load_dwordx4 v12, s[12:15], s32 offen offset:0 nt lds
    s_and_b32 s84, s85, 15
    s_lshl_b32 s84, s84, 13
    s_lshr_b32 s85, s85, 4
    s_lshl_b32 s85, s85, 18
    v_mfma_f32_16x16x32_bf16 v[224:227], v[52:55], v[96:99], v[224:227]
    v_mfma_f32_16x16x32_bf16 v[228:231], v[52:55], v[100:103], v[228:231]
    buffer_load_dwordx4 v13, s[12:15], s32 offen offset:1024 nt lds
    s_add_u32 s32, s32, 8192
    s_add_u32 s84, s84, s85
    s_add_u32 s84, s84, s87
    v_mfma_f32_16x16x32_bf16 v[232:235], v[56:59], v[88:91], v[232:235]
    v_mfma_f32_16x16x32_bf16 v[236:239], v[56:59], v[92:95], v[236:239]
    s_mov_b64 exec, 1048575
    buffer_load_dword v5, v7, s[72:75], s84 offen offset:1536
    s_mov_b64 exec, -1
    s_cmp_ge_u32 s33, s50
    s_cselect_b32 s55, 98304, 0
    s_sub_u32 s33, s33, s55
    v_mfma_f32_16x16x32_bf16 v[240:243], v[56:59], v[96:99], v[240:243]
    v_mfma_f32_16x16x32_bf16 v[244:247], v[56:59], v[100:103], v[244:247]
    s_waitcnt vmcnt(5)
    s_cmp_lt_u32 s44, 4
    s_cbranch_scc1 L_o2_0
    s_branch L_o2_done
L_o2_1:
    s_barrier
    ds_read_b64_tr_b16 v[36:37], v27 offset:0
    ds_read_b64_tr_b16 v[38:39], v27 offset:6144
    ds_read_b64_tr_b16 v[40:41], v28 offset:0
    ds_read_b64_tr_b16 v[42:43], v28 offset:6144
    ds_read_b64_tr_b16 v[44:45], v29 offset:0
    ds_read_b64_tr_b16 v[46:47], v29 offset:6144
    ds_read_b64_tr_b16 v[48:49], v27 offset:12288
    ds_read_b64_tr_b16 v[50:51], v27 offset:18432
    ds_read_b64_tr_b16 v[52:53], v28 offset:12288
    ds_read_b64_tr_b16 v[54:55], v28 offset:18432
    ds_read_b64_tr_b16 v[56:57], v29 offset:12288
    ds_read_b64_tr_b16 v[58:59], v29 offset:18432
    s_waitcnt lgkmcnt(0)
    s_barrier
    ds_read_b128 v[72:75], v33 offset:0
    ds_read_b128 v[76:79], v33 offset:2048
    ds_read_b128 v[80:83], v33 offset:4096
    ds_read_b128 v[84:87], v33 offset:6144
    ds_read_b128 v[88:91], v34 offset:0
    ds_read_b128 v[92:95], v34 offset:2048
    ds_read_b128 v[96:99], v34 offset:4096
    ds_read_b128 v[100:103], v34 offset:6144
    s_add_u32 s46, s41, s43
    s_and_b32 s46, s46, 3
    s_lshr_b32 s47, s41, 2
    s_lshl_b32 s47, s47, 2
    s_add_u32 s46, s46, s47
    s_mul_i32 s46, s46, 73728
    s_add_u32 s46, s46, s91
    s_add_u32 s47, s53, s52
    s_mov_b32 m0, s47
    s_add_u32 s46, s46, s42
    buffer_load_dwordx4 v16, s[24:27], s46 offen offset:0 lds
    s_waitcnt lgkmcnt(7)
    v_mfma_f32_16x16x32_bf16 v[104:107], v[36:39], v[72:75], v[104:107]
    s_waitcnt lgkmcnt(6)
    v_mfma_f32_16x16x32_bf16 v[108:111], v[36:39], v[76:79], v[108:111]
    buffer_load_dwordx4 v17, s[24:27], s46 offen offset:1024 lds
    s_waitcnt lgkmcnt(5)
    v_mfma_f32_16x16x32_bf16 v[112:115], v[36:39], v[80:83], v[112:115]
    s_waitcnt lgkmcnt(4)
    v_mfma_f32_16x16x32_bf16 v[116:119], v[36:39], v[84:87], v[116:119]
    buffer_load_dwordx4 v18, s[24:27], s46 offen offset:2048 lds
    v_mfma_f32_16x16x32_bf16 v[120:123], v[40:43], v[72:75], v[120:123]
    v_mfma_f32_16x16x32_bf16 v[124:127], v[40:43], v[76:79], v[124:127]
    buffer_load_dwordx4 v19, s[24:27], s46 offen offset:3072 lds
    v_mfma_f32_16x16x32_bf16 v[128:131], v[40:43], v[80:83], v[128:131]
    s_add_u32 m0, s47, 4096
    s_nop 0
    buffer_load_dwordx4 v20, s[24:27], s46 offen offset:0 lds
    v_mfma_f32_16x16x32_bf16 v[132:135], v[40:43], v[84:87], v[132:135]
    v_mfma_f32_16x16x32_bf16 v[136:139], v[44:47], v[72:75], v[136:139]
    buffer_load_dwordx4 v21, s[24:27], s46 offen offset:1024 lds
    s_add_u32 s91, s91, 384
    s_cmp_eq_u32 s91, 1152
    s_cselect_b32 s91, 0, s91
    s_addc_u32 s41, s41, 0
    v_mfma_f32_16x16x32_bf16 v[140:143], v[44:47], v[76:79], v[140:143]
    v_mfma_f32_16x16x32_bf16 v[144:147], v[44:47], v[80:83], v[144:147]
    s_mov_b32 m0, s33
    s_cmp_eq_u32 s34, 15
    buffer_load_dwordx4 v8, s[8:11], s32 offen offset:0 nt lds
    s_cselect_b32 s55, 131072, 0
    s_add_u32 s55, s55, 8192
    s_add_u32 s34, s34, 1
    v_mfma_f32_16x16x32_bf16 v[148:151], v[44:47], v[84:87], v[148:151]
    buffer_load_dwordx4 v9, s[8:11], s32 offen offset:1024 nt lds
    s_waitcnt lgkmcnt(3)
    v_mfma_f32_16x16x32_bf16 v[104:107], v[48:51], v[88:91], v[104:107]
    s_waitcnt lgkmcnt(2)
    v_mfma_f32_16x16x32_bf16 v[108:111], v[48:51], v[92:95], v[108:111]
    buffer_load_dwordx4 v10, s[8:11], s32 offen offset:2048 nt lds
    s_waitcnt lgkmcnt(1)
    v_mfma_f32_16x16x32_bf16 v[112:115], v[48:51], v[96:99], v[112:115]
    s_waitcnt lgkmcnt(0)
    v_mfma_f32_16x16x32_bf16 v[116:119], v[48:51], v[100:103], v[116:119]
    buffer_load_dwordx4 v11, s[8:11], s32 offen offset:3072 nt lds
    v_mfma_f32_16x16x32_bf16 v[120:123], v[52:55], v[88:91], v[120:123]
    v_mfma_f32_16x16x32_bf16 v[124:127], v[52:55], v[92:95], v[124:127]
    s_add_u32 m0, s33, 16384
    s_add_u32 s33, s33, 32768
    buffer_load_dwordx4 v12, s[12:15], s32 offen offset:0 nt lds
    v_mfma_f32_16x16x32_bf16 v[128:131], v[52:55], v[96:99], v[128:131]
    buffer_load_dwordx4 v13, s[12:15], s32 offen offset:1024 nt lds
    v_mfma_f32_16x16x32_bf16 v[132:135], v[52:55], v[100:103], v[132:135]
    v_mfma_f32_16x16x32_bf16 v[136:139], v[56:59], v[88:91], v[136:139]
    buffer_load_dwordx4 v12, s[12:15], s32 offen offset:2048 nt lds
    v_mfma_f32_16x16x32_bf16 v[140:143], v[56:59], v[92:95], v[140:143]
    v_mfma_f32_16x16x32_bf16 v[144:147], v[56:59], v[96:99], v[144:147]
    buffer_load_dwordx4 v13, s[12:15], s32 offen offset:3072 nt lds
    s_add_u32 s32, s32, s55
    s_cmp_ge_u32 s33, s50
    s_cselect_b32 s55, 98304, 0
    s_sub_u32 s33, s33, s55
    v_mfma_f32_16x16x32_bf16 v[148:151], v[56:59], v[100:103], v[148:151]
    s_add_u32 s44, s44, 1
    s_add_u32 s46, s43, s44
    s_and_b32 s46, s46, 3
    s_lshl_b32 s46, s46, 13
    v_add_u32 v33, s46, v31
    v_add_u32 v34, s46, v32
    s_waitcnt vmcnt(8)
    s_barrier
    ds_read_b64_tr_b16 v[36:37], v27 offset:0
    ds_read_b64_tr_b16 v[38:39], v27 offset:6144
    ds_read_b64_tr_b16 v[40:41], v28 offset:0
    ds_read_b64_tr_b16 v[42:43], v28 offset:6144
    ds_read_b64_tr_b16 v[44:45], v29 offset:0
    ds_read_b64_tr_b16 v[46:47], v29 offset:6144
    ds_read_b64_tr_b16 v[48:49], v27 offset:12288
    ds_read_b64_tr_b16 v[50:51], v27 offset:18432
    ds_read_b64_tr_b16 v[52:53], v28 offset:12288
    ds_read_b64_tr_b16 v[54:55], v28 offset:18432
    ds_read_b64_tr_b16 v[56:57], v29 offset:12288
    ds_read_b64_tr_b16 v[58:59], v29 offset:18432
    s_waitcnt lgkmcnt(0)
    s_barrier
    s_add_u32 s46, s41, s43
    s_and_b32 s46, s46, 3
    s_lshr_b32 s47, s41, 2
    s_lshl_b32 s47, s47, 2
    s_add_u32 s46, s46, s47
    s_mul_i32 s46, s46, 73728
    s_add_u32 s46, s46, s91
    s_add_u32 s47, s53, s52
    s_mov_b32 m0, s47
    s_add_u32 s46, s46, s42
    buffer_load_dwordx4 v16, s[24:27], s46 offen offset:0 lds
    v_mfma_f32_16x16x32_bf16 v[152:155], v[36:39], v[72:75], v[152:155]
    v_mfma_f32_16x16x32_bf16 v[156:159], v[36:39], v[76:79], v[156:159]
    buffer_load_dwordx4 v17, s[24:27], s46 offen offset:1024 lds
    v_mfma_f32_16x16x32_bf16 v[160:163], v[36:39], v[80:83], v[160:163]
    v_mfma_f32_16x16x32_bf16 v[164:167], v[36:39], v[84:87], v[164:167]
    buffer_load_dwordx4 v18, s[24:27], s46 offen offset:2048 lds
    v_mfma_f32_16x16x32_bf16 v[168:171], v[40:43], v[72:75], v[168:171]
    v_mfma_f32_16x16x32_bf16 v[172:175], v[40:43], v[76:79], v[172:175]
    buffer_load_dwordx4 v19, s[24:27], s46 offen offset:3072 lds
    v_mfma_f32_16x16x32_bf16 v[176:179], v[40:43], v[80:83], v[176:179]
    s_add_u32 m0, s47, 4096
    s_nop 0
    buffer_load_dwordx4 v20, s[24:27], s46 offen offset:0 lds
    v_mfma_f32_16x16x32_bf16 v[180:183], v[40:43], v[84:87], v[180:183]
    v_mfma_f32_16x16x32_bf16 v[184:187], v[44:47], v[72:75], v[184:187]
    buffer_load_dwordx4 v21, s[24:27], s46 offen offset:1024 lds
    s_add_u32 s91, s91, 384
    s_cmp_eq_u32 s91, 1152
    s_cselect_b32 s91, 0, s91
    s_addc_u32 s41, s41, 0
    v_mfma_f32_16x16x32_bf16 v[188:191], v[44:47], v[76:79], v[188:191]
    v_mfma_f32_16x16x32_bf16 v[192:195], v[44:47], v[80:83], v[192:195]
    s_mov_b32 m0, s33
    s_cmp_eq_u32 s34, 15
    buffer_load_dwordx4 v8, s[8:11], s32 offen offset:0 nt lds
    s_cselect_b32 s55, 131072, 0
    s_add_u32 s55, s55, 8192
    s_add_u32 s34, s34, 1
    v_mfma_f32_16x16x32_bf16 v[196:199], v[44:47], v[84:87], v[196:199]
    buffer_load_dwordx4 v9, s[8:11], s32 offen offset:1024 nt lds
    v_mfma_f32_16x16x32_bf16 v[152:155], v[48:51], v[88:91], v[152:155]
    v_mfma_f32_16x16x32_bf16 v[156:159], v[48:51], v[92:95], v[156:159]
    buffer_load_dwordx4 v10, s[8:11], s32 offen offset:2048 nt lds
    v_mfma_f32_16x16x32_bf16 v[160:163], v[48:51], v[96:99], v[160:163]
    v_mfma_f32_16x16x32_bf16 v[164:167], v[48:51], v[100:103], v[164:167]
    buffer_load_dwordx4 v11, s[8:11], s32 offen offset:3072 nt lds
    v_mfma_f32_16x16x32_bf16 v[168:171], v[52:55], v[88:91], v[168:171]
    v_mfma_f32_16x16x32_bf16 v[172:175], v[52:55], v[92:95], v[172:175]
    s_add_u32 m0, s33, 16384
    s_add_u32 s33, s33, 32768
    buffer_load_dwordx4 v12, s[12:15], s32 offen offset:0 nt lds
    v_mfma_f32_16x16x32_bf16 v[176:179], v[52:55], v[96:99], v[176:179]
    buffer_load_dwordx4 v13, s[12:15], s32 offen offset:1024 nt lds
    v_mfma_f32_16x16x32_bf16 v[180:183], v[52:55], v[100:103], v[180:183]
    v_mfma_f32_16x16x32_bf16 v[184:187], v[56:59], v[88:91], v[184:187]
    buffer_load_dwordx4 v12, s[12:15], s32 offen offset:2048 nt lds
    v_mfma_f32_16x16x32_bf16 v[188:191], v[56:59], v[92:95], v[188:191]
    v_mfma_f32_16x16x32_bf16 v[192:195], v[56:59], v[96:99], v[192:195]
    buffer_load_dwordx4 v13, s[12:15], s32 offen offset:3072 nt lds
    s_add_u32 s32, s32, s55
    s_cmp_ge_u32 s33, s50
    s_cselect_b32 s55, 98304, 0
    s_sub_u32 s33, s33, s55
    v_mfma_f32_16x16x32_bf16 v[196:199], v[56:59], v[100:103], v[196:199]
    s_waitcnt vmcnt(8)
    s_barrier
    ds_read_b64_tr_b16 v[36:37], v27 offset:0
    ds_read_b64_tr_b16 v[38:39], v27 offset:6144
    ds_read_b64_tr_b16 v[40:41], v28 offset:0
    ds_read_b64_tr_b16 v[42:43], v28 offset:6144
    ds_read_b64_tr_b16 v[44:45], v29 offset:0
    ds_read_b64_tr_b16 v[46:47], v29 offset:6144
    ds_read_b64_tr_b16 v[48:49], v27 offset:12288
    ds_read_b64_tr_b16 v[50:51], v27 offset:18432
    ds_read_b64_tr_b16 v[52:53], v28 offset:12288
    ds_read_b64_tr_b16 v[54:55], v28 offset:18432
    ds_read_b64_tr_b16 v[56:57], v29 offset:12288
    ds_read_b64_tr_b16 v[58:59], v29 offset:18432
    s_waitcnt lgkmcnt(0)
    s_barrier
    s_add_u32 s46, s41, s43
    s_and_b32 s46, s46, 3
    s_lshr_b32 s47, s41, 2
    s_lshl_b32 s47, s47, 2
    s_add_u32 s46, s46, s47
    s_mul_i32 s46, s46, 73728
    s_add_u32 s46, s46, s91
    s_add_u32 s47, s53, s52
    s_mov_b32 m0, s47
    s_add_u32 s46, s46, s42
    buffer_load_dwordx4 v16, s[24:27], s46 offen offset:0 lds
    v_mfma_f32_16x16x32_bf16 v[200:203], v[36:39], v[72:75], v[200:203]
    v_mfma_f32_16x16x32_bf16 v[204:207], v[36:39], v[76:79], v[204:207]
    buffer_load_dwordx4 v17, s[24:27], s46 offen offset:1024 lds
    v_mfma_f32_16x16x32_bf16 v[208:211], v[36:39], v[80:83], v[208:211]
    v_mfma_f32_16x16x32_bf16 v[212:215], v[36:39], v[84:87], v[212:215]
    buffer_load_dwordx4 v18, s[24:27], s46 offen offset:2048 lds
    v_mfma_f32_16x16x32_bf16 v[216:219], v[40:43], v[72:75], v[216:219]
    v_mfma_f32_16x16x32_bf16 v[220:223], v[40:43], v[76:79], v[220:223]
    buffer_load_dwordx4 v19, s[24:27], s46 offen offset:3072 lds
    v_mfma_f32_16x16x32_bf16 v[224:227], v[40:43], v[80:83], v[224:227]
    s_add_u32 m0, s47, 4096
    s_nop 0
    buffer_load_dwordx4 v20, s[24:27], s46 offen offset:0 lds
    v_mfma_f32_16x16x32_bf16 v[228:231], v[40:43], v[84:87], v[228:231]
    v_mfma_f32_16x16x32_bf16 v[232:235], v[44:47], v[72:75], v[232:235]
    buffer_load_dwordx4 v21, s[24:27], s46 offen offset:1024 lds
    s_add_u32 s91, s91, 384
    s_cmp_eq_u32 s91, 1152
    s_cselect_b32 s91, 0, s91
    s_addc_u32 s41, s41, 0
    v_mfma_f32_16x16x32_bf16 v[236:239], v[44:47], v[76:79], v[236:239]
    v_mfma_f32_16x16x32_bf16 v[240:243], v[44:47], v[80:83], v[240:243]
    s_mov_b32 m0, s33
    s_cmp_eq_u32 s34, 15
    buffer_load_dwordx4 v8, s[8:11], s32 offen offset:0 nt lds
    s_cselect_b32 s55, 131072, 0
    s_add_u32 s55, s55, 8192
    s_add_u32 s34, s34, 1
    v_mfma_f32_16x16x32_bf16 v[244:247], v[44:47], v[84:87], v[244:247]
    buffer_load_dwordx4 v9, s[8:11], s32 offen offset:1024 nt lds
    v_mfma_f32_16x16x32_bf16 v[200:203], v[48:51], v[88:91], v[200:203]
    v_mfma_f32_16x16x32_bf16 v[204:207], v[48:51], v[92:95], v[204:207]
    buffer_load_dwordx4 v10, s[8:11], s32 offen offset:2048 nt lds
    v_mfma_f32_16x16x32_bf16 v[208:211], v[48:51], v[96:99], v[208:211]
    v_mfma_f32_16x16x32_bf16 v[212:215], v[48:51], v[100:103], v[212:215]
    buffer_load_dwordx4 v11, s[8:11], s32 offen offset:3072 nt lds
    v_mfma_f32_16x16x32_bf16 v[216:219], v[52:55], v[88:91], v[216:219]
    v_mfma_f32_16x16x32_bf16 v[220:223], v[52:55], v[92:95], v[220:223]
    s_add_u32 m0, s33, 16384
    s_add_u32 s33, s33, 32768
    buffer_load_dwordx4 v12, s[12:15], s32 offen offset:0 nt lds
    v_mfma_f32_16x16x32_bf16 v[224:227], v[52:55], v[96:99], v[224:227]
    buffer_load_dwordx4 v13, s[12:15], s32 offen offset:1024 nt lds
    v_mfma_f32_16x16x32_bf16 v[228:231], v[52:55], v[100:103], v[228:231]
    v_mfma_f32_16x16x32_bf16 v[232:235], v[56:59], v[88:91], v[232:235]
    buffer_load_dwordx4 v12, s[12:15], s32 offen offset:2048 nt lds
    v_mfma_f32_16x16x32_bf16 v[236:239], v[56:59], v[92:95], v[236:239]
    v_mfma_f32_16x16x32_bf16 v[240:243], v[56:59], v[96:99], v[240:243]
    buffer_load_dwordx4 v13, s[12:15], s32 offen offset:3072 nt lds
    s_add_u32 s32, s32, s55
    s_cmp_ge_u32 s33, s50
    s_cselect_b32 s55, 98304, 0
    s_sub_u32 s33, s33, s55
    v_mfma_f32_16x16x32_bf16 v[244:247], v[56:59], v[100:103], v[244:247]
    s_waitcnt vmcnt(8)
    s_cmp_lt_u32 s44, 4
    s_cbranch_scc1 L_o2_1
L_o2_done:
    s_barrier
    s_barrier
    s_call_b64 s[64:65], F_kv
    v_lshl_add_u32 v1, v0, 2, s60
    v_cmp_gt_u32 vcc, 6, v0
    s_and_saveexec_b64 s[46:47], vcc
    s_cmp_lg_u32 s4, 0
    s_cbranch_scc1 L_nz
    ds_write_b32 v1, v35 offset:24576
L_nz:
    s_mov_b64 exec, -1
    s_waitcnt lgkmcnt(0)
    s_waitcnt vmcnt(8)
    s_cmp_eq_u32 s55, 8
    s_cbranch_scc1 L_kw7
    s_waitcnt vmcnt(5)
    s_cmp_eq_u32 s55, 4
    s_cbranch_scc1 L_kw7
    s_waitcnt vmcnt(0)
L_kw7:
    s_mov_b32 s76, s82
    s_and_b32 s77, s83, 0xffff
    s_mov_b32 s78, 256
    s_mov_b32 s79, 0x20000
    s_lshl_b32 s48, s7, 2
    s_barrier
    s_barrier
    buffer_load_dword v5, v35, s[76:79], s48 offen offset:0 sc1
    s_mov_b32 s53, s61
    s_call_b64 s[64:65], F_wo
    s_waitcnt vmcnt(6)
    v_readfirstlane_b32 s47, v5
    s_cmp_ge_u32 s47, 16
    s_cbranch_scc1 L_init_ok
    s_mov_b32 s76, s82
    s_and_b32 s77, s83, 0xffff
    s_mov_b32 s78, 256
    s_mov_b32 s79, 0x20000
    s_lshl_b32 s48, s7, 2
    s_mov_b32 s89, 65536
L_sp8:
    buffer_load_dword v5, v35, s[76:79], s48 offen offset:0 sc1
    s_waitcnt vmcnt(0) lgkmcnt(0)
    v_readfirstlane_b32 s47, v5
    s_cmp_ge_u32 s47, 16
    s_cbranch_scc1 L_se9
    s_sleep 1
    s_sub_u32 s89, s89, 1
    s_cmp_lg_u32 s89, 0
    s_cbranch_scc1 L_sp8
L_se9:
L_init_ok:
    s_barrier
    s_barrier
    s_mov_b32 s53, s62
    s_call_b64 s[64:65], F_wo
    s_setprio 0
    ds_read_b64_tr_b16 v[36:37], v27 offset:0
    ds_read_b64_tr_b16 v[38:39], v27 offset:6144
    ds_read_b64_tr_b16 v[40:41], v28 offset:0
    ds_read_b64_tr_b16 v[42:43], v28 offset:6144
    ds_read_b64_tr_b16 v[44:45], v29 offset:0
    ds_read_b64_tr_b16 v[46:47], v29 offset:6144
    ds_read_b64_tr_b16 v[48:49], v27 offset:12288
    ds_read_b64_tr_b16 v[50:51], v27 offset:18432
    ds_read_b64_tr_b16 v[52:53], v28 offset:12288
    ds_read_b64_tr_b16 v[54:55], v28 offset:18432
    ds_read_b64_tr_b16 v[56:57], v29 offset:12288
    ds_read_b64_tr_b16 v[58:59], v29 offset:18432
    s_waitcnt lgkmcnt(0)
    s_barrier
    ds_read_b128 v[72:75], v33 offset:0
    ds_read_b128 v[76:79], v33 offset:2048
    ds_read_b128 v[80:83], v33 offset:4096
    ds_read_b128 v[84:87], v33 offset:6144
    ds_read_b128 v[88:91], v34 offset:0
    ds_read_b128 v[92:95], v34 offset:2048
    ds_read_b128 v[96:99], v34 offset:4096
    ds_read_b128 v[100:103], v34 offset:6144
    s_waitcnt lgkmcnt(7)
    v_mfma_f32_16x16x32_bf16 v[104:107], v[36:39], v[72:75], v[104:107]
    s_waitcnt lgkmcnt(6)
    v_mfma_f32_16x16x32_bf16 v[108:111], v[36:39], v[76:79], v[108:111]
    s_waitcnt lgkmcnt(5)
    v_mfma_f32_16x16x32_bf16 v[112:115], v[36:39], v[80:83], v[112:115]
    s_waitcnt lgkmcnt(4)
    v_mfma_f32_16x16x32_bf16 v[116:119], v[36:39], v[84:87], v[116:119]
    v_mfma_f32_16x16x32_bf16 v[120:123], v[40:43], v[72:75], v[120:123]
    v_mfma_f32_16x16x32_bf16 v[124:127], v[40:43], v[76:79], v[124:127]
    v_mfma_f32_16x16x32_bf16 v[128:131], v[40:43], v[80:83], v[128:131]
    v_mfma_f32_16x16x32_bf16 v[132:135], v[40:43], v[84:87], v[132:135]
    v_add_u32 v27, s61, v24
    v_add_u32 v28, s61, v25
    v_mfma_f32_16x16x32_bf16 v[136:139], v[44:47], v[72:75], v[136:139]
    v_add_u32 v29, s61, v26
    v_mfma_f32_16x16x32_bf16 v[140:143], v[44:47], v[76:79], v[140:143]
    v_mfma_f32_16x16x32_bf16 v[144:147], v[44:47], v[80:83], v[144:147]
    s_waitcnt lgkmcnt(0)
    v_mfma_f32_16x16x32_bf16 v[148:151], v[44:47], v[84:87], v[148:151]
    s_waitcnt vmcnt(6)
    s_barrier
    ds_read_b64_tr_b16 v[36:37], v27 offset:0
    v_mfma_f32_16x16x32_bf16 v[104:107], v[48:51], v[88:91], v[104:107]
    ds_read_b64_tr_b16 v[38:39], v27 offset:6144
    v_mfma_f32_16x16x32_bf16 v[108:111], v[48:51], v[92:95], v[108:111]
    ds_read_b64_tr_b16 v[40:41], v28 offset:0
    v_mfma_f32_16x16x32_bf16 v[112:115], v[48:51], v[96:99], v[112:115]
    ds_read_b64_tr_b16 v[42:43], v28 offset:6144
    v_mfma_f32_16x16x32_bf16 v[116:119], v[48:51], v[100:103], v[116:119]
    ds_read_b64_tr_b16 v[44:45], v29 offset:0
    v_mfma_f32_16x16x32_bf16 v[120:123], v[52:55], v[88:91], v[120:123]
    ds_read_b64_tr_b16 v[46:47], v29 offset:6144
    v_mfma_f32_16x16x32_bf16 v[124:127], v[52:55], v[92:95], v[124:127]
    ds_read_b64_tr_b16 v[60:61], v27 offset:12288
    v_mfma_f32_16x16x32_bf16 v[128:131], v[52:55], v[96:99], v[128:131]
    ds_read_b64_tr_b16 v[62:63], v27 offset:18432
    v_mfma_f32_16x16x32_bf16 v[132:135], v[52:55], v[100:103], v[132:135]
    ds_read_b64_tr_b16 v[64:65], v28 offset:12288
    v_mfma_f32_16x16x32_bf16 v[136:139], v[56:59], v[88:91], v[136:139]
    ds_read_b64_tr_b16 v[66:67], v28 offset:18432
    v_mfma_f32_16x16x32_bf16 v[140:143], v[56:59], v[92:95], v[140:143]
    ds_read_b64_tr_b16 v[68:69], v29 offset:12288
    v_mfma_f32_16x16x32_bf16 v[144:147], v[56:59], v[96:99], v[144:147]
    ds_read_b64_tr_b16 v[70:71], v29 offset:18432
    v_mfma_f32_16x16x32_bf16 v[148:151], v[56:59], v[100:103], v[148:151]
    s_waitcnt lgkmcnt(6)
    v_mfma_f32_16x16x32_bf16 v[152:155], v[36:39], v[72:75], v[152:155]
    v_mfma_f32_16x16x32_bf16 v[156:159], v[36:39], v[76:79], v[156:159]
    v_mfma_f32_16x16x32_bf16 v[160:163], v[36:39], v[80:83], v[160:163]
    v_mfma_f32_16x16x32_bf16 v[164:167], v[36:39], v[84:87], v[164:167]
    v_mfma_f32_16x16x32_bf16 v[168:171], v[40:43], v[72:75], v[168:171]
    v_add_u32 v27, s62, v24
    v_mfma_f32_16x16x32_bf16 v[172:175], v[40:43], v[76:79], v[172:175]
    v_add_u32 v28, s62, v25
    v_mfma_f32_16x16x32_bf16 v[176:179], v[40:43], v[80:83], v[176:179]
    v_add_u32 v29, s62, v26
    v_mfma_f32_16x16x32_bf16 v[180:183], v[40:43], v[84:87], v[180:183]
    v_mfma_f32_16x16x32_bf16 v[184:187], v[44:47], v[72:75], v[184:187]
    v_mfma_f32_16x16x32_bf16 v[188:191], v[44:47], v[76:79], v[188:191]
    v_mfma_f32_16x16x32_bf16 v[192:195], v[44:47], v[80:83], v[192:195]
    s_waitcnt lgkmcnt(0)
    v_mfma_f32_16x16x32_bf16 v[196:199], v[44:47], v[84:87], v[196:199]
    s_waitcnt vmcnt(0)
    s_barrier
    ds_read_b64_tr_b16 v[36:37], v27 offset:0
    v_mfma_f32_16x16x32_bf16 v[152:155], v[60:63], v[88:91], v[152:155]
    ds_read_b64_tr_b16 v[38:39], v27 offset:6144
    v_mfma_f32_16x16x32_bf16 v[156:159], v[60:63], v[92:95], v[156:159]
    ds_read_b64_tr_b16 v[40:41], v28 offset:0
    v_mfma_f32_16x16x32_bf16 v[160:163], v[60:63], v[96:99], v[160:163]
    ds_read_b64_tr_b16 v[42:43], v28 offset:6144
    v_mfma_f32_16x16x32_bf16 v[164:167], v[60:63], v[100:103], v[164:167]
    ds_read_b64_tr_b16 v[44:45], v29 offset:0
    v_mfma_f32_16x16x32_bf16 v[168:171], v[64:67], v[88:91], v[168:171]
    ds_read_b64_tr_b16 v[46:47], v29 offset:6144
    v_mfma_f32_16x16x32_bf16 v[172:175], v[64:67], v[92:95], v[172:175]
    ds_read_b64_tr_b16 v[48:49], v27 offset:12288
    v_mfma_f32_16x16x32_bf16 v[176:179], v[64:67], v[96:99], v[176:179]
    ds_read_b64_tr_b16 v[50:51], v27 offset:18432
    v_mfma_f32_16x16x32_bf16 v[180:183], v[64:67], v[100:103], v[180:183]
    ds_read_b64_tr_b16 v[52:53], v28 offset:12288
    v_mfma_f32_16x16x32_bf16 v[184:187], v[68:71], v[88:91], v[184:187]
    ds_read_b64_tr_b16 v[54:55], v28 offset:18432
    v_mfma_f32_16x16x32_bf16 v[188:191], v[68:71], v[92:95], v[188:191]
    ds_read_b64_tr_b16 v[56:57], v29 offset:12288
    v_mfma_f32_16x16x32_bf16 v[192:195], v[68:71], v[96:99], v[192:195]
    ds_read_b64_tr_b16 v[58:59], v29 offset:18432
    v_mfma_f32_16x16x32_bf16 v[196:199], v[68:71], v[100:103], v[196:199]
    s_waitcnt lgkmcnt(6)
    v_mfma_f32_16x16x32_bf16 v[200:203], v[36:39], v[72:75], v[200:203]
    v_mfma_f32_16x16x32_bf16 v[204:207], v[36:39], v[76:79], v[204:207]
    v_mfma_f32_16x16x32_bf16 v[208:211], v[36:39], v[80:83], v[208:211]
    v_mfma_f32_16x16x32_bf16 v[212:215], v[36:39], v[84:87], v[212:215]
    v_mfma_f32_16x16x32_bf16 v[216:219], v[40:43], v[72:75], v[216:219]
    v_add_u32 v27, s63, v24
    v_mfma_f32_16x16x32_bf16 v[220:223], v[40:43], v[76:79], v[220:223]
    v_add_u32 v28, s63, v25
    v_mfma_f32_16x16x32_bf16 v[224:227], v[40:43], v[80:83], v[224:227]
    v_add_u32 v29, s63, v26
    v_mfma_f32_16x16x32_bf16 v[228:231], v[40:43], v[84:87], v[228:231]
    s_add_u32 s46, s43, 1
    s_and_b32 s46, s46, 3
    s_lshl_b32 s46, s46, 13
    v_mfma_f32_16x16x32_bf16 v[232:235], v[44:47], v[72:75], v[232:235]
    v_add_u32 v33, s46, v31
    v_mfma_f32_16x16x32_bf16 v[236:239], v[44:47], v[76:79], v[236:239]
    v_add_u32 v34, s46, v32
    v_mfma_f32_16x16x32_bf16 v[240:243], v[44:47], v[80:83], v[240:243]
    s_waitcnt lgkmcnt(0)
    v_mfma_f32_16x16x32_bf16 v[244:247], v[44:47], v[84:87], v[244:247]
    s_barrier
    ds_read_b128 v[72:75], v33 offset:0
    ds_read_b64_tr_b16 v[36:37], v27 offset:0
    v_mfma_f32_16x16x32_bf16 v[200:203], v[48:51], v[88:91], v[200:203]
    ds_read_b64_tr_b16 v[38:39], v27 offset:6144
    ds_read_b128 v[76:79], v33 offset:2048
    v_mfma_f32_16x16x32_bf16 v[204:207], v[48:51], v[92:95], v[204:207]
    ds_read_b128 v[80:83], v33 offset:4096
    ds_read_b128 v[84:87], v33 offset:6144
    v_mfma_f32_16x16x32_bf16 v[208:211], v[48:51], v[96:99], v[208:211]
    ds_read_b64_tr_b16 v[40:41], v28 offset:0
    ds_read_b64_tr_b16 v[42:43], v28 offset:6144
    v_mfma_f32_16x16x32_bf16 v[212:215], v[48:51], v[100:103], v[212:215]
    ds_read_b64_tr_b16 v[44:45], v29 offset:0
    ds_read_b64_tr_b16 v[46:47], v29 offset:6144
    v_mfma_f32_16x16x32_bf16 v[216:219], v[52:55], v[88:91], v[216:219]
    v_mfma_f32_16x16x32_bf16 v[220:223], v[52:55], v[92:95], v[220:223]
    ds_read_b64_tr_b16 v[60:61], v27 offset:12288
    v_mfma_f32_16x16x32_bf16 v[224:227], v[52:55], v[96:99], v[224:227]
    ds_read_b64_tr_b16 v[62:63], v27 offset:18432
    v_mfma_f32_16x16x32_bf16 v[228:231], v[52:55], v[100:103], v[228:231]
    ds_read_b64_tr_b16 v[64:65], v28 offset:12288
    v_mfma_f32_16x16x32_bf16 v[232:235], v[56:59], v[88:91], v[232:235]
    ds_read_b64_tr_b16 v[66:67], v28 offset:18432
    v_mfma_f32_16x16x32_bf16 v[236:239], v[56:59], v[92:95], v[236:239]
    ds_read_b64_tr_b16 v[68:69], v29 offset:12288
    v_mfma_f32_16x16x32_bf16 v[240:243], v[56:59], v[96:99], v[240:243]
    s_waitcnt lgkmcnt(14)
    ds_read_b64_tr_b16 v[70:71], v29 offset:18432
    v_mfma_f32_16x16x32_bf16 v[244:247], v[56:59], v[100:103], v[244:247]
    s_waitcnt lgkmcnt(6)
    v_mfma_f32_16x16x32_bf16 v[104:107], v[36:39], v[72:75], v[104:107]
    ds_read_b128 v[88:91], v34 offset:0
    v_mfma_f32_16x16x32_bf16 v[108:111], v[36:39], v[76:79], v[108:111]
    ds_read_b128 v[92:95], v34 offset:2048
    v_mfma_f32_16x16x32_bf16 v[112:115], v[36:39], v[80:83], v[112:115]
    ds_read_b128 v[96:99], v34 offset:4096
    v_mfma_f32_16x16x32_bf16 v[116:119], v[36:39], v[84:87], v[116:119]
    ds_read_b128 v[100:103], v34 offset:6144
    v_mfma_f32_16x16x32_bf16 v[120:123], v[40:43], v[72:75], v[120:123]
    v_add_u32 v27, s60, v24
    v_mfma_f32_16x16x32_bf16 v[124:127], v[40:43], v[76:79], v[124:127]
    v_add_u32 v28, s60, v25
    v_mfma_f32_16x16x32_bf16 v[128:131], v[40:43], v[80:83], v[128:131]
    v_add_u32 v29, s60, v26
    v_mfma_f32_16x16x32_bf16 v[132:135], v[40:43], v[84:87], v[132:135]
    v_mfma_f32_16x16x32_bf16 v[136:139], v[44:47], v[72:75], v[136:139]
    v_mfma_f32_16x16x32_bf16 v[140:143], v[44:47], v[76:79], v[140:143]
    v_mfma_f32_16x16x32_bf16 v[144:147], v[44:47], v[80:83], v[144:147]
    s_waitcnt lgkmcnt(0)
    v_mfma_f32_16x16x32_bf16 v[148:151], v[44:47], v[84:87], v[148:151]
    s_barrier
    ds_read_b64_tr_b16 v[36:37], v27 offset:0
    v_mfma_f32_16x16x32_bf16 v[104:107], v[60:63], v[88:91], v[104:107]
    ds_read_b64_tr_b16 v[38:39], v27 offset:6144
    v_mfma_f32_16x16x32_bf16 v[108:111], v[60:63], v[92:95], v[108:111]
    ds_read_b64_tr_b16 v[40:41], v28 offset:0
    v_mfma_f32_16x16x32_bf16 v[112:115], v[60:63], v[96:99], v[112:115]
    ds_read_b64_tr_b16 v[42:43], v28 offset:6144
    v_mfma_f32_16x16x32_bf16 v[116:119], v[60:63], v[100:103], v[116:119]
    ds_read_b64_tr_b16 v[44:45], v29 offset:0
    v_mfma_f32_16x16x32_bf16 v[120:123], v[64:67], v[88:91], v[120:123]
    ds_read_b64_tr_b16 v[46:47], v29 offset:6144
    v_mfma_f32_16x16x32_bf16 v[124:127], v[64:67], v[92:95], v[124:127]
    ds_read_b64_tr_b16 v[48:49], v27 offset:12288
    v_mfma_f32_16x16x32_bf16 v[128:131], v[64:67], v[96:99], v[128:131]
    ds_read_b64_tr_b16 v[50:51], v27 offset:18432
    v_mfma_f32_16x16x32_bf16 v[132:135], v[64:67], v[100:103], v[132:135]
    ds_read_b64_tr_b16 v[52:53], v28 offset:12288
    v_mfma_f32_16x16x32_bf16 v[136:139], v[68:71], v[88:91], v[136:139]
    ds_read_b64_tr_b16 v[54:55], v28 offset:18432
    v_mfma_f32_16x16x32_bf16 v[140:143], v[68:71], v[92:95], v[140:143]
    ds_read_b64_tr_b16 v[56:57], v29 offset:12288
    v_mfma_f32_16x16x32_bf16 v[144:147], v[68:71], v[96:99], v[144:147]
    ds_read_b64_tr_b16 v[58:59], v29 offset:18432
    v_mfma_f32_16x16x32_bf16 v[148:151], v[68:71], v[100:103], v[148:151]
    s_waitcnt lgkmcnt(6)
    v_mfma_f32_16x16x32_bf16 v[152:155], v[36:39], v[72:75], v[152:155]
    v_mfma_f32_16x16x32_bf16 v[156:159], v[36:39], v[76:79], v[156:159]
    v_mfma_f32_16x16x32_bf16 v[160:163], v[36:39], v[80:83], v[160:163]
    v_mfma_f32_16x16x32_bf16 v[164:167], v[36:39], v[84:87], v[164:167]
    v_mfma_f32_16x16x32_bf16 v[168:171], v[40:43], v[72:75], v[168:171]
    v_add_u32 v27, s61, v24
    v_mfma_f32_16x16x32_bf16 v[172:175], v[40:43], v[76:79], v[172:175]
    v_add_u32 v28, s61, v25
    v_mfma_f32_16x16x32_bf16 v[176:179], v[40:43], v[80:83], v[176:179]
    v_add_u32 v29, s61, v26
    v_mfma_f32_16x16x32_bf16 v[180:183], v[40:43], v[84:87], v[180:183]
    v_mfma_f32_16x16x32_bf16 v[184:187], v[44:47], v[72:75], v[184:187]
    v_mfma_f32_16x16x32_bf16 v[188:191], v[44:47], v[76:79], v[188:191]
    v_mfma_f32_16x16x32_bf16 v[192:195], v[44:47], v[80:83], v[192:195]
    s_waitcnt lgkmcnt(0)
    v_mfma_f32_16x16x32_bf16 v[196:199], v[44:47], v[84:87], v[196:199]
    s_barrier
    ds_read_b64_tr_b16 v[36:37], v27 offset:0
    v_mfma_f32_16x16x32_bf16 v[152:155], v[48:51], v[88:91], v[152:155]
    ds_read_b64_tr_b16 v[38:39], v27 offset:6144
    v_mfma_f32_16x16x32_bf16 v[156:159], v[48:51], v[92:95], v[156:159]
    ds_read_b64_tr_b16 v[40:41], v28 offset:0
    v_mfma_f32_16x16x32_bf16 v[160:163], v[48:51], v[96:99], v[160:163]
    ds_read_b64_tr_b16 v[42:43], v28 offset:6144
    v_mfma_f32_16x16x32_bf16 v[164:167], v[48:51], v[100:103], v[164:167]
    ds_read_b64_tr_b16 v[44:45], v29 offset:0
    v_mfma_f32_16x16x32_bf16 v[168:171], v[52:55], v[88:91], v[168:171]
    ds_read_b64_tr_b16 v[46:47], v29 offset:6144
    v_mfma_f32_16x16x32_bf16 v[172:175], v[52:55], v[92:95], v[172:175]
    ds_read_b64_tr_b16 v[60:61], v27 offset:12288
    v_mfma_f32_16x16x32_bf16 v[176:179], v[52:55], v[96:99], v[176:179]
    ds_read_b64_tr_b16 v[62:63], v27 offset:18432
    v_mfma_f32_16x16x32_bf16 v[180:183], v[52:55], v[100:103], v[180:183]
    ds_read_b64_tr_b16 v[64:65], v28 offset:12288
    v_mfma_f32_16x16x32_bf16 v[184:187], v[56:59], v[88:91], v[184:187]
    ds_read_b64_tr_b16 v[66:67], v28 offset:18432
    v_mfma_f32_16x16x32_bf16 v[188:191], v[56:59], v[92:95], v[188:191]
    ds_read_b64_tr_b16 v[68:69], v29 offset:12288
    v_mfma_f32_16x16x32_bf16 v[192:195], v[56:59], v[96:99], v[192:195]
    ds_read_b64_tr_b16 v[70:71], v29 offset:18432
    v_mfma_f32_16x16x32_bf16 v[196:199], v[56:59], v[100:103], v[196:199]
    s_waitcnt lgkmcnt(6)
    v_mfma_f32_16x16x32_bf16 v[200:203], v[36:39], v[72:75], v[200:203]
    v_mfma_f32_16x16x32_bf16 v[204:207], v[36:39], v[76:79], v[204:207]
    v_mfma_f32_16x16x32_bf16 v[208:211], v[36:39], v[80:83], v[208:211]
    v_mfma_f32_16x16x32_bf16 v[212:215], v[36:39], v[84:87], v[212:215]
    v_mfma_f32_16x16x32_bf16 v[216:219], v[40:43], v[72:75], v[216:219]
    v_add_u32 v27, s62, v24
    v_mfma_f32_16x16x32_bf16 v[220:223], v[40:43], v[76:79], v[220:223]
    v_add_u32 v28, s62, v25
    v_mfma_f32_16x16x32_bf16 v[224:227], v[40:43], v[80:83], v[224:227]
    v_add_u32 v29, s62, v26
    v_mfma_f32_16x16x32_bf16 v[228:231], v[40:43], v[84:87], v[228:231]
    s_add_u32 s46, s43, 2
    s_and_b32 s46, s46, 3
    s_lshl_b32 s46, s46, 13
    v_mfma_f32_16x16x32_bf16 v[232:235], v[44:47], v[72:75], v[232:235]
    v_add_u32 v33, s46, v31
    v_mfma_f32_16x16x32_bf16 v[236:239], v[44:47], v[76:79], v[236:239]
    v_add_u32 v34, s46, v32
    v_mfma_f32_16x16x32_bf16 v[240:243], v[44:47], v[80:83], v[240:243]
    s_waitcnt lgkmcnt(0)
    v_mfma_f32_16x16x32_bf16 v[244:247], v[44:47], v[84:87], v[244:247]
    s_barrier
    ds_read_b128 v[72:75], v33 offset:0
    ds_read_b64_tr_b16 v[36:37], v27 offset:0
    v_mfma_f32_16x16x32_bf16 v[200:203], v[60:63], v[88:91], v[200:203]
    ds_read_b64_tr_b16 v[38:39], v27 offset:6144
    ds_read_b128 v[76:79], v33 offset:2048
    v_mfma_f32_16x16x32_bf16 v[204:207], v[60:63], v[92:95], v[204:207]
    ds_read_b128 v[80:83], v33 offset:4096
    ds_read_b128 v[84:87], v33 offset:6144
    v_mfma_f32_16x16x32_bf16 v[208:211], v[60:63], v[96:99], v[208:211]
    ds_read_b64_tr_b16 v[40:41], v28 offset:0
    ds_read_b64_tr_b16 v[42:43], v28 offset:6144
    v_mfma_f32_16x16x32_bf16 v[212:215], v[60:63], v[100:103], v[212:215]
    ds_read_b64_tr_b16 v[44:45], v29 offset:0
    ds_read_b64_tr_b16 v[46:47], v29 offset:6144
    v_mfma_f32_16x16x32_bf16 v[216:219], v[64:67], v[88:91], v[216:219]
    v_mfma_f32_16x16x32_bf16 v[220:223], v[64:67], v[92:95], v[220:223]
    ds_read_b64_tr_b16 v[48:49], v27 offset:12288
    v_mfma_f32_16x16x32_bf16 v[224:227], v[64:67], v[96:99], v[224:227]
    ds_read_b64_tr_b16 v[50:51], v27 offset:18432
    v_mfma_f32_16x16x32_bf16 v[228:231], v[64:67], v[100:103], v[228:231]
    ds_read_b64_tr_b16 v[52:53], v28 offset:12288
    v_mfma_f32_16x16x32_bf16 v[232:235], v[68:71], v[88:91], v[232:235]
    ds_read_b64_tr_b16 v[54:55], v28 offset:18432
    v_mfma_f32_16x16x32_bf16 v[236:239], v[68:71], v[92:95], v[236:239]
    ds_read_b64_tr_b16 v[56:57], v29 offset:12288
    v_mfma_f32_16x16x32_bf16 v[240:243], v[68:71], v[96:99], v[240:243]
    s_waitcnt lgkmcnt(14)
    ds_read_b64_tr_b16 v[58:59], v29 offset:18432
    v_mfma_f32_16x16x32_bf16 v[244:247], v[68:71], v[100:103], v[244:247]
    s_waitcnt lgkmcnt(6)
    v_mfma_f32_16x16x32_bf16 v[104:107], v[36:39], v[72:75], v[104:107]
    ds_read_b128 v[88:91], v34 offset:0
    v_mfma_f32_16x16x32_bf16 v[108:111], v[36:39], v[76:79], v[108:111]
    ds_read_b128 v[92:95], v34 offset:2048
    v_mfma_f32_16x16x32_bf16 v[112:115], v[36:39], v[80:83], v[112:115]
    ds_read_b128 v[96:99], v34 offset:4096
    v_mfma_f32_16x16x32_bf16 v[116:119], v[36:39], v[84:87], v[116:119]
    ds_read_b128 v[100:103], v34 offset:6144
    v_mfma_f32_16x16x32_bf16 v[120:123], v[40:43], v[72:75], v[120:123]
    v_add_u32 v27, s63, v24
    v_mfma_f32_16x16x32_bf16 v[124:127], v[40:43], v[76:79], v[124:127]
    v_add_u32 v28, s63, v25
    v_mfma_f32_16x16x32_bf16 v[128:131], v[40:43], v[80:83], v[128:131]
    v_add_u32 v29, s63, v26
    v_mfma_f32_16x16x32_bf16 v[132:135], v[40:43], v[84:87], v[132:135]
    s_add_u32 s46, s43, 3
    s_and_b32 s46, s46, 3
    s_lshl_b32 s46, s46, 13
    v_mfma_f32_16x16x32_bf16 v[136:139], v[44:47], v[72:75], v[136:139]
    v_add_u32 v33, s46, v31
    v_mfma_f32_16x16x32_bf16 v[140:143], v[44:47], v[76:79], v[140:143]
    v_add_u32 v34, s46, v32
    v_mfma_f32_16x16x32_bf16 v[144:147], v[44:47], v[80:83], v[144:147]
    s_waitcnt lgkmcnt(0)
    v_mfma_f32_16x16x32_bf16 v[148:151], v[44:47], v[84:87], v[148:151]
    s_barrier
    ds_read_b128 v[72:75], v33 offset:0
    ds_read_b64_tr_b16 v[36:37], v27 offset:0
    v_mfma_f32_16x16x32_bf16 v[104:107], v[48:51], v[88:91], v[104:107]
    ds_read_b64_tr_b16 v[38:39], v27 offset:6144
    ds_read_b128 v[76:79], v33 offset:2048
    v_mfma_f32_16x16x32_bf16 v[108:111], v[48:51], v[92:95], v[108:111]
    ds_read_b128 v[80:83], v33 offset:4096
    ds_read_b128 v[84:87], v33 offset:6144
    v_mfma_f32_16x16x32_bf16 v[112:115], v[48:51], v[96:99], v[112:115]
    ds_read_b64_tr_b16 v[40:41], v28 offset:0
    ds_read_b64_tr_b16 v[42:43], v28 offset:6144
    v_mfma_f32_16x16x32_bf16 v[116:119], v[48:51], v[100:103], v[116:119]
    ds_read_b64_tr_b16 v[44:45], v29 offset:0
    ds_read_b64_tr_b16 v[46:47], v29 offset:6144
    v_mfma_f32_16x16x32_bf16 v[120:123], v[52:55], v[88:91], v[120:123]
    v_mfma_f32_16x16x32_bf16 v[124:127], v[52:55], v[92:95], v[124:127]
    ds_read_b64_tr_b16 v[60:61], v27 offset:12288
    v_mfma_f32_16x16x32_bf16 v[128:131], v[52:55], v[96:99], v[128:131]
    ds_read_b64_tr_b16 v[62:63], v27 offset:18432
    v_mfma_f32_16x16x32_bf16 v[132:135], v[52:55], v[100:103], v[132:135]
    ds_read_b64_tr_b16 v[64:65], v28 offset:12288
    v_mfma_f32_16x16x32_bf16 v[136:139], v[56:59], v[88:91], v[136:139]
    ds_read_b64_tr_b16 v[66:67], v28 offset:18432
    v_mfma_f32_16x16x32_bf16 v[140:143], v[56:59], v[92:95], v[140:143]
    ds_read_b64_tr_b16 v[68:69], v29 offset:12288
    v_mfma_f32_16x16x32_bf16 v[144:147], v[56:59], v[96:99], v[144:147]
    s_waitcnt lgkmcnt(14)
    ds_read_b64_tr_b16 v[70:71], v29 offset:18432
    v_mfma_f32_16x16x32_bf16 v[148:151], v[56:59], v[100:103], v[148:151]
    s_waitcnt lgkmcnt(6)
    v_mfma_f32_16x16x32_bf16 v[104:107], v[36:39], v[72:75], v[104:107]
    ds_read_b128 v[88:91], v34 offset:0
    v_mfma_f32_16x16x32_bf16 v[108:111], v[36:39], v[76:79], v[108:111]
    ds_read_b128 v[92:95], v34 offset:2048
    v_mfma_f32_16x16x32_bf16 v[112:115], v[36:39], v[80:83], v[112:115]
    ds_read_b128 v[96:99], v34 offset:4096
    v_mfma_f32_16x16x32_bf16 v[116:119], v[36:39], v[84:87], v[116:119]
    ds_read_b128 v[100:103], v34 offset:6144
    v_mfma_f32_16x16x32_bf16 v[120:123], v[40:43], v[72:75], v[120:123]
    v_add_u32 v27, s60, v24
    v_mfma_f32_16x16x32_bf16 v[124:127], v[40:43], v[76:79], v[124:127]
    v_add_u32 v28, s60, v25
    v_mfma_f32_16x16x32_bf16 v[128:131], v[40:43], v[80:83], v[128:131]
    v_add_u32 v29, s60, v26
    v_mfma_f32_16x16x32_bf16 v[132:135], v[40:43], v[84:87], v[132:135]
    s_add_u32 s46, s43, 2
    s_and_b32 s46, s46, 3
    s_lshl_b32 s46, s46, 13
    v_mfma_f32_16x16x32_bf16 v[136:139], v[44:47], v[72:75], v[136:139]
    v_add_u32 v33, s46, v31
    v_mfma_f32_16x16x32_bf16 v[140:143], v[44:47], v[76:79], v[140:143]
    v_add_u32 v34, s46, v32
    v_mfma_f32_16x16x32_bf16 v[144:147], v[44:47], v[80:83], v[144:147]
    s_waitcnt lgkmcnt(0)
    v_mfma_f32_16x16x32_bf16 v[148:151], v[44:47], v[84:87], v[148:151]
    s_barrier
    ds_read_b128 v[72:75], v33 offset:0
    ds_read_b64_tr_b16 v[36:37], v27 offset:0
    v_mfma_f32_16x16x32_bf16 v[104:107], v[60:63], v[88:91], v[104:107]
    ds_read_b64_tr_b16 v[38:39], v27 offset:6144
    ds_read_b128 v[76:79], v33 offset:2048
    v_mfma_f32_16x16x32_bf16 v[108:111], v[60:63], v[92:95], v[108:111]
    ds_read_b128 v[80:83], v33 offset:4096
    ds_read_b128 v[84:87], v33 offset:6144
    v_mfma_f32_16x16x32_bf16 v[112:115], v[60:63], v[96:99], v[112:115]
    ds_read_b64_tr_b16 v[40:41], v28 offset:0
    ds_read_b64_tr_b16 v[42:43], v28 offset:6144
    v_mfma_f32_16x16x32_bf16 v[116:119], v[60:63], v[100:103], v[116:119]
    ds_read_b64_tr_b16 v[44:45], v29 offset:0
    ds_read_b64_tr_b16 v[46:47], v29 offset:6144
    v_mfma_f32_16x16x32_bf16 v[120:123], v[64:67], v[88:91], v[120:123]
    v_mfma_f32_16x16x32_bf16 v[124:127], v[64:67], v[92:95], v[124:127]
    ds_read_b64_tr_b16 v[48:49], v27 offset:12288
    v_mfma_f32_16x16x32_bf16 v[128:131], v[64:67], v[96:99], v[128:131]
    ds_read_b64_tr_b16 v[50:51], v27 offset:18432
    v_mfma_f32_16x16x32_bf16 v[132:135], v[64:67], v[100:103], v[132:135]
    ds_read_b64_tr_b16 v[52:53], v28 offset:12288
    v_mfma_f32_16x16x32_bf16 v[136:139], v[68:71], v[88:91], v[136:139]
    ds_read_b64_tr_b16 v[54:55], v28 offset:18432
    v_mfma_f32_16x16x32_bf16 v[140:143], v[68:71], v[92:95], v[140:143]
    ds_read_b64_tr_b16 v[56:57], v29 offset:12288
    v_mfma_f32_16x16x32_bf16 v[144:147], v[68:71], v[96:99], v[144:147]
    s_waitcnt lgkmcnt(14)
    ds_read_b64_tr_b16 v[58:59], v29 offset:18432
    v_mfma_f32_16x16x32_bf16 v[148:151], v[68:71], v[100:103], v[148:151]
    v_cvt_pk_bf16_f32 v104, v104, v105
    v_cvt_pk_bf16_f32 v105, v106, v107
    v_cvt_pk_bf16_f32 v106, v108, v109
    v_cvt_pk_bf16_f32 v107, v110, v111
    buffer_store_dwordx4 v[104:107], v30, s[28:31], s45 offen offset:0 sc1
    s_waitcnt lgkmcnt(6)
    v_mfma_f32_16x16x32_bf16 v[152:155], v[36:39], v[72:75], v[152:155]
    ds_read_b128 v[88:91], v34 offset:0
    v_mfma_f32_16x16x32_bf16 v[156:159], v[36:39], v[76:79], v[156:159]
    ds_read_b128 v[92:95], v34 offset:2048
    v_mfma_f32_16x16x32_bf16 v[160:163], v[36:39], v[80:83], v[160:163]
    ds_read_b128 v[96:99], v34 offset:4096
    v_cvt_pk_bf16_f32 v112, v112, v113
    v_cvt_pk_bf16_f32 v113, v114, v115
    v_cvt_pk_bf16_f32 v114, v116, v117
    v_cvt_pk_bf16_f32 v115, v118, v119
    buffer_store_dwordx4 v[112:115], v30, s[28:31], s45 offen offset:1024 sc1
    v_mfma_f32_16x16x32_bf16 v[164:167], v[36:39], v[84:87], v[164:167]
    ds_read_b128 v[100:103], v34 offset:6144
    v_mfma_f32_16x16x32_bf16 v[168:171], v[40:43], v[72:75], v[168:171]
    v_add_u32 v27, s61, v24
    v_mfma_f32_16x16x32_bf16 v[172:175], v[40:43], v[76:79], v[172:175]
    v_add_u32 v28, s61, v25
    v_cvt_pk_bf16_f32 v120, v120, v121
    v_cvt_pk_bf16_f32 v121, v122, v123
    v_cvt_pk_bf16_f32 v122, v124, v125
    v_cvt_pk_bf16_f32 v123, v126, v127
    buffer_store_dwordx4 v[120:123], v30, s[28:31], s45 offen offset:2048 sc1
    v_mfma_f32_16x16x32_bf16 v[176:179], v[40:43], v[80:83], v[176:179]
    v_add_u32 v29, s61, v26
    v_mfma_f32_16x16x32_bf16 v[180:183], v[40:43], v[84:87], v[180:183]
    s_add_u32 s46, s43, 3
    s_and_b32 s46, s46, 3
    s_lshl_b32 s46, s46, 13
    v_mfma_f32_16x16x32_bf16 v[184:187], v[44:47], v[72:75], v[184:187]
    v_add_u32 v33, s46, v31
    v_cvt_pk_bf16_f32 v128, v128, v129
    v_cvt_pk_bf16_f32 v129, v130, v131
    v_cvt_pk_bf16_f32 v130, v132, v133
    v_cvt_pk_bf16_f32 v131, v134, v135
    buffer_store_dwordx4 v[128:131], v30, s[28:31], s45 offen offset:3072 sc1
    s_add_u32 s45, s45, 4096
    v_mfma_f32_16x16x32_bf16 v[188:191], v[44:47], v[76:79], v[188:191]
    v_add_u32 v34, s46, v32
    v_mfma_f32_16x16x32_bf16 v[192:195], v[44:47], v[80:83], v[192:195]
    s_waitcnt lgkmcnt(0)
    v_mfma_f32_16x16x32_bf16 v[196:199], v[44:47], v[84:87], v[196:199]
    v_cvt_pk_bf16_f32 v136, v136, v137
    v_cvt_pk_bf16_f32 v137, v138, v139
    v_cvt_pk_bf16_f32 v138, v140, v141
    v_cvt_pk_bf16_f32 v139, v142, v143
    buffer_store_dwordx4 v[136:139], v30, s[28:31], s45 offen offset:0 sc1
    s_barrier
    ds_read_b128 v[72:75], v33 offset:0
    ds_read_b64_tr_b16 v[36:37], v27 offset:0
    v_mfma_f32_16x16x32_bf16 v[152:155], v[48:51], v[88:91], v[152:155]
    ds_read_b64_tr_b16 v[38:39], v27 offset:6144
    ds_read_b128 v[76:79], v33 offset:2048
    v_mfma_f32_16x16x32_bf16 v[156:159], v[48:51], v[92:95], v[156:159]
    ds_read_b128 v[80:83], v33 offset:4096
    ds_read_b128 v[84:87], v33 offset:6144
    v_mfma_f32_16x16x32_bf16 v[160:163], v[48:51], v[96:99], v[160:163]
    ds_read_b64_tr_b16 v[40:41], v28 offset:0
    ds_read_b64_tr_b16 v[42:43], v28 offset:6144
    v_cvt_pk_bf16_f32 v144, v144, v145
    v_cvt_pk_bf16_f32 v145, v146, v147
    v_cvt_pk_bf16_f32 v146, v148, v149
    v_cvt_pk_bf16_f32 v147, v150, v151
    buffer_store_dwordx4 v[144:147], v30, s[28:31], s45 offen offset:1024 sc1
    s_add_u32 s45, s45, 20480
    v_mfma_f32_16x16x32_bf16 v[164:167], v[48:51], v[100:103], v[164:167]
    ds_read_b64_tr_b16 v[44:45], v29 offset:0
    ds_read_b64_tr_b16 v[46:47], v29 offset:6144
    v_mfma_f32_16x16x32_bf16 v[168:171], v[52:55], v[88:91], v[168:171]
    v_mfma_f32_16x16x32_bf16 v[172:175], v[52:55], v[92:95], v[172:175]
    ds_read_b64_tr_b16 v[60:61], v27 offset:12288
    v_mfma_f32_16x16x32_bf16 v[176:179], v[52:55], v[96:99], v[176:179]
    ds_read_b64_tr_b16 v[62:63], v27 offset:18432
    v_mfma_f32_16x16x32_bf16 v[180:183], v[52:55], v[100:103], v[180:183]
    ds_read_b64_tr_b16 v[64:65], v28 offset:12288
    v_mfma_f32_16x16x32_bf16 v[184:187], v[56:59], v[88:91], v[184:187]
    ds_read_b64_tr_b16 v[66:67], v28 offset:18432
    v_mfma_f32_16x16x32_bf16 v[188:191], v[56:59], v[92:95], v[188:191]
    ds_read_b64_tr_b16 v[68:69], v29 offset:12288
    v_mfma_f32_16x16x32_bf16 v[192:195], v[56:59], v[96:99], v[192:195]
    s_waitcnt lgkmcnt(14)
    ds_read_b64_tr_b16 v[70:71], v29 offset:18432
    v_mfma_f32_16x16x32_bf16 v[196:199], v[56:59], v[100:103], v[196:199]
    s_waitcnt lgkmcnt(6)
    v_mfma_f32_16x16x32_bf16 v[152:155], v[36:39], v[72:75], v[152:155]
    ds_read_b128 v[88:91], v34 offset:0
    v_mfma_f32_16x16x32_bf16 v[156:159], v[36:39], v[76:79], v[156:159]
    ds_read_b128 v[92:95], v34 offset:2048
    v_mfma_f32_16x16x32_bf16 v[160:163], v[36:39], v[80:83], v[160:163]
    ds_read_b128 v[96:99], v34 offset:4096
    v_mfma_f32_16x16x32_bf16 v[164:167], v[36:39], v[84:87], v[164:167]
    ds_read_b128 v[100:103], v34 offset:6144
    v_mfma_f32_16x16x32_bf16 v[168:171], v[40:43], v[72:75], v[168:171]
    v_add_u32 v27, s62, v24
    v_mfma_f32_16x16x32_bf16 v[172:175], v[40:43], v[76:79], v[172:175]
    v_add_u32 v28, s62, v25
    v_mfma_f32_16x16x32_bf16 v[176:179], v[40:43], v[80:83], v[176:179]
    v_add_u32 v29, s62, v26
    v_mfma_f32_16x16x32_bf16 v[180:183], v[40:43], v[84:87], v[180:183]
    s_add_u32 s46, s43, 2
    s_and_b32 s46, s46, 3
    s_lshl_b32 s46, s46, 13
    v_mfma_f32_16x16x32_bf16 v[184:187], v[44:47], v[72:75], v[184:187]
    v_add_u32 v33, s46, v31
    v_mfma_f32_16x16x32_bf16 v[188:191], v[44:47], v[76:79], v[188:191]
    v_add_u32 v34, s46, v32
    v_mfma_f32_16x16x32_bf16 v[192:195], v[44:47], v[80:83], v[192:195]
    s_waitcnt lgkmcnt(0)
    v_mfma_f32_16x16x32_bf16 v[196:199], v[44:47], v[84:87], v[196:199]
    s_barrier
    ds_read_b128 v[72:75], v33 offset:0
    ds_read_b64_tr_b16 v[36:37], v27 offset:0
    v_mfma_f32_16x16x32_bf16 v[152:155], v[60:63], v[88:91], v[152:155]
    ds_read_b64_tr_b16 v[38:39], v27 offset:6144
    ds_read_b128 v[76:79], v33 offset:2048
    v_mfma_f32_16x16x32_bf16 v[156:159], v[60:63], v[92:95], v[156:159]
    ds_read_b128 v[80:83], v33 offset:4096
    ds_read_b128 v[84:87], v33 offset:6144
    v_mfma_f32_16x16x32_bf16 v[160:163], v[60:63], v[96:99], v[160:163]
    ds_read_b64_tr_b16 v[40:41], v28 offset:0
    ds_read_b64_tr_b16 v[42:43], v28 offset:6144
    v_mfma_f32_16x16x32_bf16 v[164:167], v[60:63], v[100:103], v[164:167]
    ds_read_b64_tr_b16 v[44:45], v29 offset:0
    ds_read_b64_tr_b16 v[46:47], v29 offset:6144
    v_mfma_f32_16x16x32_bf16 v[168:171], v[64:67], v[88:91], v[168:171]
    v_mfma_f32_16x16x32_bf16 v[172:175], v[64:67], v[92:95], v[172:175]
    ds_read_b64_tr_b16 v[48:49], v27 offset:12288
    v_mfma_f32_16x16x32_bf16 v[176:179], v[64:67], v[96:99], v[176:179]
    ds_read_b64_tr_b16 v[50:51], v27 offset:18432
    v_mfma_f32_16x16x32_bf16 v[180:183], v[64:67], v[100:103], v[180:183]
    ds_read_b64_tr_b16 v[52:53], v28 offset:12288
    v_mfma_f32_16x16x32_bf16 v[184:187], v[68:71], v[88:91], v[184:187]
    ds_read_b64_tr_b16 v[54:55], v28 offset:18432
    v_mfma_f32_16x16x32_bf16 v[188:191], v[68:71], v[92:95], v[188:191]
    ds_read_b64_tr_b16 v[56:57], v29 offset:12288
    v_mfma_f32_16x16x32_bf16 v[192:195], v[68:71], v[96:99], v[192:195]
    s_waitcnt lgkmcnt(14)
    ds_read_b64_tr_b16 v[58:59], v29 offset:18432
    v_mfma_f32_16x16x32_bf16 v[196:199], v[68:71], v[100:103], v[196:199]
    v_cvt_pk_bf16_f32 v152, v152, v153
    v_cvt_pk_bf16_f32 v153, v154, v155
    v_cvt_pk_bf16_f32 v154, v156, v157
    v_cvt_pk_bf16_f32 v155, v158, v159
    buffer_store_dwordx4 v[152:155], v30, s[28:31], s45 offen offset:0 sc1
    s_waitcnt lgkmcnt(6)
    v_mfma_f32_16x16x32_bf16 v[200:203], v[36:39], v[72:75], v[200:203]
    ds_read_b128 v[88:91], v34 offset:0
    v_mfma_f32_16x16x32_bf16 v[204:207], v[36:39], v[76:79], v[204:207]
    ds_read_b128 v[92:95], v34 offset:2048
    v_mfma_f32_16x16x32_bf16 v[208:211], v[36:39], v[80:83], v[208:211]
    ds_read_b128 v[96:99], v34 offset:4096
    v_cvt_pk_bf16_f32 v160, v160, v161
    v_cvt_pk_bf16_f32 v161, v162, v163
    v_cvt_pk_bf16_f32 v162, v164, v165
    v_cvt_pk_bf16_f32 v163, v166, v167
    buffer_store_dwordx4 v[160:163], v30, s[28:31], s45 offen offset:1024 sc1
    v_mfma_f32_16x16x32_bf16 v[212:215], v[36:39], v[84:87], v[212:215]
    ds_read_b128 v[100:103], v34 offset:6144
    v_mfma_f32_16x16x32_bf16 v[216:219], v[40:43], v[72:75], v[216:219]
    v_add_u32 v27, s63, v24
    v_mfma_f32_16x16x32_bf16 v[220:223], v[40:43], v[76:79], v[220:223]
    v_add_u32 v28, s63, v25
    v_cvt_pk_bf16_f32 v168, v168, v169
    v_cvt_pk_bf16_f32 v169, v170, v171
    v_cvt_pk_bf16_f32 v170, v172, v173
    v_cvt_pk_bf16_f32 v171, v174, v175
    buffer_store_dwordx4 v[168:171], v30, s[28:31], s45 offen offset:2048 sc1
    v_mfma_f32_16x16x32_bf16 v[224:227], v[40:43], v[80:83], v[224:227]
    v_add_u32 v29, s63, v26
    v_mfma_f32_16x16x32_bf16 v[228:231], v[40:43], v[84:87], v[228:231]
    s_add_u32 s46, s43, 3
    s_and_b32 s46, s46, 3
    s_lshl_b32 s46, s46, 13
    v_mfma_f32_16x16x32_bf16 v[232:235], v[44:47], v[72:75], v[232:235]
    v_add_u32 v33, s46, v31
    v_cvt_pk_bf16_f32 v176, v176, v177
    v_cvt_pk_bf16_f32 v177, v178, v179
    v_cvt_pk_bf16_f32 v178, v180, v181
    v_cvt_pk_bf16_f32 v179, v182, v183
    buffer_store_dwordx4 v[176:179], v30, s[28:31], s45 offen offset:3072 sc1
    s_add_u32 s45, s45, 4096
    v_mfma_f32_16x16x32_bf16 v[236:239], v[44:47], v[76:79], v[236:239]
    v_add_u32 v34, s46, v32
    v_mfma_f32_16x16x32_bf16 v[240:243], v[44:47], v[80:83], v[240:243]
    s_waitcnt lgkmcnt(0)
    v_mfma_f32_16x16x32_bf16 v[244:247], v[44:47], v[84:87], v[244:247]
    v_cvt_pk_bf16_f32 v184, v184, v185
    v_cvt_pk_bf16_f32 v185, v186, v187
    v_cvt_pk_bf16_f32 v186, v188, v189
    v_cvt_pk_bf16_f32 v187, v190, v191
    buffer_store_dwordx4 v[184:187], v30, s[28:31], s45 offen offset:0 sc1
    s_barrier
    ds_read_b128 v[72:75], v33 offset:0
    ds_read_b64_tr_b16 v[36:37], v27 offset:0
    v_mfma_f32_16x16x32_bf16 v[200:203], v[48:51], v[88:91], v[200:203]
    ds_read_b64_tr_b16 v[38:39], v27 offset:6144
    ds_read_b128 v[76:79], v33 offset:2048
    v_mfma_f32_16x16x32_bf16 v[204:207], v[48:51], v[92:95], v[204:207]
    ds_read_b128 v[80:83], v33 offset:4096
    ds_read_b128 v[84:87], v33 offset:6144
    v_mfma_f32_16x16x32_bf16 v[208:211], v[48:51], v[96:99], v[208:211]
    ds_read_b64_tr_b16 v[40:41], v28 offset:0
    ds_read_b64_tr_b16 v[42:43], v28 offset:6144
    v_cvt_pk_bf16_f32 v192, v192, v193
    v_cvt_pk_bf16_f32 v193, v194, v195
    v_cvt_pk_bf16_f32 v194, v196, v197
    v_cvt_pk_bf16_f32 v195, v198, v199
    buffer_store_dwordx4 v[192:195], v30, s[28:31], s45 offen offset:1024 sc1
    s_add_u32 s45, s45, 20480
    v_mfma_f32_16x16x32_bf16 v[212:215], v[48:51], v[100:103], v[212:215]
    ds_read_b64_tr_b16 v[44:45], v29 offset:0
    ds_read_b64_tr_b16 v[46:47], v29 offset:6144
    v_mfma_f32_16x16x32_bf16 v[216:219], v[52:55], v[88:91], v[216:219]
    v_mfma_f32_16x16x32_bf16 v[220:223], v[52:55], v[92:95], v[220:223]
    ds_read_b64_tr_b16 v[60:61], v27 offset:12288
    v_mfma_f32_16x16x32_bf16 v[224:227], v[52:55], v[96:99], v[224:227]
    ds_read_b64_tr_b16 v[62:63], v27 offset:18432
    v_mfma_f32_16x16x32_bf16 v[228:231], v[52:55], v[100:103], v[228:231]
    ds_read_b64_tr_b16 v[64:65], v28 offset:12288
    v_mfma_f32_16x16x32_bf16 v[232:235], v[56:59], v[88:91], v[232:235]
    ds_read_b64_tr_b16 v[66:67], v28 offset:18432
    v_mfma_f32_16x16x32_bf16 v[236:239], v[56:59], v[92:95], v[236:239]
    ds_read_b64_tr_b16 v[68:69], v29 offset:12288
    v_mfma_f32_16x16x32_bf16 v[240:243], v[56:59], v[96:99], v[240:243]
    s_waitcnt lgkmcnt(14)
    ds_read_b64_tr_b16 v[70:71], v29 offset:18432
    v_mfma_f32_16x16x32_bf16 v[244:247], v[56:59], v[100:103], v[244:247]
    s_waitcnt lgkmcnt(6)
    v_mfma_f32_16x16x32_bf16 v[200:203], v[36:39], v[72:75], v[200:203]
    ds_read_b128 v[88:91], v34 offset:0
    v_mfma_f32_16x16x32_bf16 v[204:207], v[36:39], v[76:79], v[204:207]
    ds_read_b128 v[92:95], v34 offset:2048
    v_mfma_f32_16x16x32_bf16 v[208:211], v[36:39], v[80:83], v[208:211]
    ds_read_b128 v[96:99], v34 offset:4096
    v_mfma_f32_16x16x32_bf16 v[212:215], v[36:39], v[84:87], v[212:215]
    ds_read_b128 v[100:103], v34 offset:6144
    v_mfma_f32_16x16x32_bf16 v[216:219], v[40:43], v[72:75], v[216:219]
    v_add_u32 v27, s60, v24
    v_mfma_f32_16x16x32_bf16 v[220:223], v[40:43], v[76:79], v[220:223]
    v_add_u32 v28, s60, v25
    v_mfma_f32_16x16x32_bf16 v[224:227], v[40:43], v[80:83], v[224:227]
    v_add_u32 v29, s60, v26
    v_mfma_f32_16x16x32_bf16 v[228:231], v[40:43], v[84:87], v[228:231]
    v_mfma_f32_16x16x32_bf16 v[232:235], v[44:47], v[72:75], v[232:235]
    v_mfma_f32_16x16x32_bf16 v[236:239], v[44:47], v[76:79], v[236:239]
    v_mfma_f32_16x16x32_bf16 v[240:243], v[44:47], v[80:83], v[240:243]
    s_waitcnt lgkmcnt(0)
    v_mfma_f32_16x16x32_bf16 v[244:247], v[44:47], v[84:87], v[244:247]
    v_mfma_f32_16x16x32_bf16 v[200:203], v[60:63], v[88:91], v[200:203]
    v_mfma_f32_16x16x32_bf16 v[204:207], v[60:63], v[92:95], v[204:207]
    v_mfma_f32_16x16x32_bf16 v[208:211], v[60:63], v[96:99], v[208:211]
    v_mfma_f32_16x16x32_bf16 v[212:215], v[60:63], v[100:103], v[212:215]
    v_mfma_f32_16x16x32_bf16 v[216:219], v[64:67], v[88:91], v[216:219]
    v_mfma_f32_16x16x32_bf16 v[220:223], v[64:67], v[92:95], v[220:223]
    v_mfma_f32_16x16x32_bf16 v[224:227], v[64:67], v[96:99], v[224:227]
    v_mfma_f32_16x16x32_bf16 v[228:231], v[64:67], v[100:103], v[228:231]
    v_mfma_f32_16x16x32_bf16 v[232:235], v[68:71], v[88:91], v[232:235]
    v_mfma_f32_16x16x32_bf16 v[236:239], v[68:71], v[92:95], v[236:239]
    v_cvt_pk_bf16_f32 v200, v200, v201
    v_cvt_pk_bf16_f32 v201, v202, v203
    v_cvt_pk_bf16_f32 v202, v204, v205
    v_cvt_pk_bf16_f32 v203, v206, v207
    buffer_store_dwordx4 v[200:203], v30, s[28:31], s45 offen offset:0 sc1
    v_mfma_f32_16x16x32_bf16 v[240:243], v[68:71], v[96:99], v[240:243]
    v_mfma_f32_16x16x32_bf16 v[244:247], v[68:71], v[100:103], v[244:247]
    v_cvt_pk_bf16_f32 v208, v208, v209
    v_cvt_pk_bf16_f32 v209, v210, v211
    v_cvt_pk_bf16_f32 v210, v212, v213
    v_cvt_pk_bf16_f32 v211, v214, v215
    buffer_store_dwordx4 v[208:211], v30, s[28:31], s45 offen offset:1024 sc1
    v_cvt_pk_bf16_f32 v216, v216, v217
    v_cvt_pk_bf16_f32 v217, v218, v219
    v_cvt_pk_bf16_f32 v218, v220, v221
    v_cvt_pk_bf16_f32 v219, v222, v223
    buffer_store_dwordx4 v[216:219], v30, s[28:31], s45 offen offset:2048 sc1
    v_cvt_pk_bf16_f32 v224, v224, v225
    v_cvt_pk_bf16_f32 v225, v226, v227
    v_cvt_pk_bf16_f32 v226, v228, v229
    v_cvt_pk_bf16_f32 v227, v230, v231
    buffer_store_dwordx4 v[224:227], v30, s[28:31], s45 offen offset:3072 sc1
    s_add_u32 s45, s45, 4096
    v_cvt_pk_bf16_f32 v232, v232, v233
    v_cvt_pk_bf16_f32 v233, v234, v235
    v_cvt_pk_bf16_f32 v234, v236, v237
    v_cvt_pk_bf16_f32 v235, v238, v239
    buffer_store_dwordx4 v[232:235], v30, s[28:31], s45 offen offset:0 sc1
    v_cvt_pk_bf16_f32 v240, v240, v241
    v_cvt_pk_bf16_f32 v241, v242, v243
    v_cvt_pk_bf16_f32 v242, v244, v245
    v_cvt_pk_bf16_f32 v243, v246, v247
    buffer_store_dwordx4 v[240:243], v30, s[28:31], s45 offen offset:1024 sc1
    s_add_u32 s45, s45, 20480
    v_mov_b32 v1, 122880
    v_mov_b32 v6, 1
    v_lshlrev_b32 v5, 4, v0
    v_mov_b32 v36, 1
    v_mov_b32 v37, 1
    v_mov_b32 v38, 1
    v_mov_b32 v39, 1
    s_lshl_b32 s46, s6, 14
    s_lshl_b32 s47, s5, 7
    s_add_u32 s46, s46, s47
    s_add_u32 s46, s46, s88
    s_mov_b64 exec, 1
    s_waitcnt vmcnt(0)
    ds_add_rtn_u32 v7, v1, v6 offset:0
    s_waitcnt lgkmcnt(0)
    v_readfirstlane_b32 s47, v7
    s_cmp_lg_u32 s47, 3
    s_cbranch_scc1 L_nf0
    s_mov_b64 exec, 0xff
    buffer_store_dwordx4 v[36:39], v5, s[28:31], s46 offen sc1
L_nf0:
    s_mov_b64 exec, -1
    s_branch L_reduce
L_end:
    s_endpgm
.section .rodata,"a"
.p2align 6
.amdhsa_kernel concat_heads__gqa_block_cached__mha_block_cached__near_ridge_kernel
  .amdhsa_next_free_vgpr 256
  .amdhsa_next_free_sgpr 102
  .amdhsa_accum_offset 256
  .amdhsa_group_segment_fixed_size 0
  .amdhsa_kernarg_size 104
  .amdhsa_user_sgpr_count 2
  .amdhsa_user_sgpr_kernarg_segment_ptr 1
  .amdhsa_system_sgpr_workgroup_id_x 1
.end_amdhsa_kernel
```
